```python
import torch

def _softmax(x, axis=-1):
    return torch.softmax(x, dim=axis)
def _gelu(x):
    return torch.nn.functional.gelu(x, approximate="tanh")
def _silu(x):
    return torch.nn.functional.silu(x)
def _sigmoid(x):
    return torch.sigmoid(x)
def _layernorm(x, axis=-1, eps=1e-5):
    m = x.mean(dim=axis, keepdim=True)
    v = x.var(dim=axis, keepdim=True, unbiased=False)
    return (x - m) / torch.sqrt(v + eps)
def _scatter_add(tgt, idx, src, axis=0):
    return tgt.clone().index_add_(axis, idx, src)
def _segment_sum(src, seg, n):
    out = torch.zeros((n,) + src.shape[1:], dtype=src.dtype)
    return out.index_add_(0, seg, src)
def _pad(x, pw):
    flat = tuple(v for pair in reversed(pw) for v in pair)
    return torch.nn.functional.pad(x, flat)

kernel_name = 'standalone__linear_kernel_rfa__prompt'

def setup_inputs():

    _w = (lambda a: (lambda t: t.to(torch.bfloat16) if t.is_floating_point() else t)(torch.as_tensor(a)))
    B, H, Sq, Sk, D, M = 1, 32, 2048, 2048, 192, 64
    return {
        "q": _w((lambda *s: torch.randn(*s, dtype=torch.bfloat16) * 0.1)(B, H, Sq, D)),
        "k": _w((lambda *s: torch.randn(*s, dtype=torch.bfloat16) * 1.6)(B, H, Sk, D)),
        "v": _w((lambda *s: torch.randn(*s, dtype=torch.bfloat16) * 1.6)(B, H, Sk, D)),
        "omega": _w((lambda *s: torch.randn(*s, dtype=torch.bfloat16) * 1.6)(M, D)),
    }

def reference(q, k, v, omega):
    d = q.shape[-1]
    m = omega.shape[0]
    scale = float(d) ** -0.25
    qs = q * scale
    ks = k * scale
    q_proj = torch.einsum("bhsd,md->bhsm", qs, omega)
    k_proj = torch.einsum("bhsd,md->bhsm", ks, omega)
    q_sq = 0.5 * torch.einsum("bhsd,bhsd->bhs", qs, qs)[..., None]
    k_sq = 0.5 * torch.einsum("bhsd,bhsd->bhs", ks, ks)[..., None]
    inv_sqrt_m = float(m) ** -0.5
    phi_q = torch.exp(q_proj - q_sq) * inv_sqrt_m + 1e-6
    phi_k = torch.exp(k_proj - k_sq) * inv_sqrt_m + 1e-6
    kv = torch.einsum("bhsm,bhsd->bhmd", phi_k, v)
    z  = torch.einsum("bhsm->bhm", phi_k)
    num = torch.einsum("bhqm,bhmd->bhqd", phi_q, kv)
    den = torch.einsum("bhqm,bhm->bhq", phi_q, z)[..., None] + 1e-6
    return num / den
```

```asm
; @launch kernel=rfa_phase1_kernel grid=(256,1,1) block=(1024,1,1) lds=156672
; @launch kernel=standalone__linear_kernel_rfa__prompt_kernel grid=(256,1,1) block=(1024,1,1) lds=51264
.amdgcn_target "amdgcn-amd-amdhsa--gfx950"
.text
.globl rfa_phase1_kernel
.p2align 8
.type rfa_phase1_kernel,@function
rfa_phase1_kernel:
    s_cmp_ge_u32 s2, 256
    s_cbranch_scc1 L_p1_end
    s_load_dwordx2 s[4:5], s[0:1], 8
    s_load_dwordx2 s[6:7], s[0:1], 16
    s_load_dwordx2 s[8:9], s[0:1], 24
    s_load_dwordx2 s[10:11], s[0:1], 48
    v_and_b32 v1, 63, v0
    v_lshrrev_b32 v12, 6, v0
    v_and_b32 v13, 15, v1
    v_readfirstlane_b32 s28, v12
    v_lshrrev_b32 v14, 4, v1
    v_mul_u32_u24 v2, 384, v13
    v_lshl_add_u32 v2, v14, 4, v2
    v_lshlrev_b32 v11, 4, v1
    s_lshr_b32 s29, s2, 3
    s_and_b32 s30, s2, 7
    s_mov_b32 s34, 0x3e898b82
    s_mov_b32 s35, 0x3fb8aa3b
    s_mov_b32 s36, 0x32a57060
    s_mov_b32 s37, 0x3f317218
    v_mov_b32 v45, 0x3e000000
    v_mov_b32 v46, 0x35860000
    s_lshl_b32 s32, s29, 11
    s_lshl_b32 s33, s30, 8
    s_add_u32 s32, s32, s33
    s_lshl_b32 s33, s28, 4
    s_add_u32 s32, s32, s33
    s_mul_i32 s31, s32, 384
    s_waitcnt lgkmcnt(0)
    s_mov_b32 s12, s4
    s_mov_b32 s13, s5
    s_mov_b32 s14, 25165824
    s_mov_b32 s15, 0x00020000
    s_mov_b32 s16, s6
    s_mov_b32 s17, s7
    s_mov_b32 s18, 25165824
    s_mov_b32 s19, 0x00020000
    s_mov_b32 s20, s8
    s_mov_b32 s21, s9
    s_mov_b32 s22, 24576
    s_mov_b32 s23, 0x00020000
    s_mov_b32 s24, s10
    s_mov_b32 s25, s11
    s_mov_b32 s26, 17833984
    s_mov_b32 s27, 0x00020000
    v_add_u32 v12, 0, v1
    v_mul_u32_u24 v13, 171, v12
    v_lshrrev_b32 v13, 12, v13
    v_mul_u32_u24 v14, 24, v13
    v_sub_u32 v14, v12, v14
    v_lshrrev_b32 v15, 1, v13
    v_and_b32 v15, 3, v15
    v_lshlrev_b32 v15, 1, v15
    v_xor_b32 v14, v14, v15
    v_mul_u32_u24 v3, 384, v13
    v_lshl_add_u32 v3, v14, 4, v3
    v_add_u32 v12, 64, v1
    v_mul_u32_u24 v13, 171, v12
    v_lshrrev_b32 v13, 12, v13
    v_mul_u32_u24 v14, 24, v13
    v_sub_u32 v14, v12, v14
    v_lshrrev_b32 v15, 1, v13
    v_and_b32 v15, 3, v15
    v_lshlrev_b32 v15, 1, v15
    v_xor_b32 v14, v14, v15
    v_mul_u32_u24 v4, 384, v13
    v_lshl_add_u32 v4, v14, 4, v4
    v_add_u32 v12, 128, v1
    v_mul_u32_u24 v13, 171, v12
    v_lshrrev_b32 v13, 12, v13
    v_mul_u32_u24 v14, 24, v13
    v_sub_u32 v14, v12, v14
    v_lshrrev_b32 v15, 1, v13
    v_and_b32 v15, 3, v15
    v_lshlrev_b32 v15, 1, v15
    v_xor_b32 v14, v14, v15
    v_mul_u32_u24 v5, 384, v13
    v_lshl_add_u32 v5, v14, 4, v5
    v_and_b32 v13, 15, v1
    v_lshrrev_b32 v14, 4, v1
    v_mul_u32_u24 v6, 2112, v14
    v_lshl_add_u32 v6, v13, 3, v6
    s_lshl_b32 s32, s28, 7
    s_add_u32 s32, s32, 24576
    v_add_u32 v6, s32, v6
    s_lshr_b32 s38, s28, 2
    s_and_b32 s39, s28, 3
    v_and_b32 v12, 3, v1
    v_lshrrev_b32 v13, 2, v1
    v_mul_u32_u24 v7, 2112, v12
    v_lshl_add_u32 v7, v13, 3, v7
    s_mul_i32 s32, s38, 8448
    s_add_u32 s32, s32, 24576
    v_add_u32 v7, s32, v7
    v_lshrrev_b32 v14, 1, v13
    v_and_b32 v14, 3, v14
    v_lshlrev_b32 v14, 1, v14
    v_lshrrev_b32 v15, 1, v12
    s_mul_i32 s32, s39, 6
    v_mul_u32_u24 v13, 384, v13
    v_and_b32 v12, 1, v12
    v_lshl_add_u32 v13, v12, 3, v13
    v_add_u32 v13, 58368, v13
    s_add_u32 s33, s32, 0
    v_add_u32 v12, s33, v15
    v_xor_b32 v12, v12, v14
    v_lshl_add_u32 v8, v12, 4, v13
    s_add_u32 s33, s32, 2
    v_add_u32 v12, s33, v15
    v_xor_b32 v12, v12, v14
    v_lshl_add_u32 v9, v12, 4, v13
    s_add_u32 s33, s32, 4
    v_add_u32 v12, s33, v15
    v_xor_b32 v12, v12, v14
    v_lshl_add_u32 v10, v12, 4, v13
    s_mul_i32 s32, s2, 52
    s_mul_i32 s33, s38, 13
    s_add_u32 s32, s32, s33
    s_mul_i32 s33, s39, 3
    s_add_u32 s32, s32, s33
    s_lshl_b32 s40, s32, 10
    s_mov_b32 s41, s28
    s_mul_i32 s32, s41, 43
    s_lshr_b32 s32, s32, 8
    s_mul_i32 s33, s32, 6
    s_sub_u32 s33, s41, s33
    s_mul_i32 s32, s32, 6144
    s_lshl_b32 s33, s33, 6
    s_add_u32 s32, s32, s33
    s_lshl_b32 s33, s41, 10
    s_add_u32 s33, s33, 0
    s_mov_b32 m0, s33
    s_nop 0
    buffer_load_dwordx4 v2, s[20:23], s32 offen lds
    s_cmp_ge_u32 s28, 8
    s_cbranch_scc1 L_om_skip_p1
    s_add_u32 s41, s28, 16
    s_mul_i32 s32, s41, 43
    s_lshr_b32 s32, s32, 8
    s_mul_i32 s33, s32, 6
    s_sub_u32 s33, s41, s33
    s_mul_i32 s32, s32, 6144
    s_lshl_b32 s33, s33, 6
    s_add_u32 s32, s32, s33
    s_lshl_b32 s33, s41, 10
    s_add_u32 s33, s33, 0
    s_mov_b32 m0, s33
    s_nop 0
    buffer_load_dwordx4 v2, s[20:23], s32 offen lds
L_om_skip_p1:
    buffer_load_dwordx4 v[16:19], v2, s[12:15], s31 offen offset:0 nt
    buffer_load_dwordx4 v[20:23], v2, s[12:15], s31 offen offset:64 nt
    s_waitcnt vmcnt(2)
    s_barrier
    buffer_load_dwordx4 v[24:27], v2, s[12:15], s31 offen offset:128 nt
    buffer_load_dwordx4 v[28:31], v2, s[12:15], s31 offen offset:192 nt
    buffer_load_dwordx4 v[32:35], v2, s[12:15], s31 offen offset:256 nt
    buffer_load_dwordx4 v[36:39], v2, s[12:15], s31 offen offset:320 nt
    v_mov_b32 v40, 0
    v_mov_b32 v41, 0
    v_mov_b32 v42, 0
    v_mov_b32 v43, 0
    s_waitcnt vmcnt(5)
    v_lshlrev_b32 v96, 16, v16
    v_and_b32 v97, 0xffff0000, v16
    v_lshlrev_b32 v98, 16, v17
    v_and_b32 v99, 0xffff0000, v17
    v_lshlrev_b32 v100, 16, v18
    v_and_b32 v101, 0xffff0000, v18
    v_lshlrev_b32 v102, 16, v19
    v_and_b32 v103, 0xffff0000, v19
    v_mul_f32 v96, s34, v96
    v_mul_f32 v97, s34, v97
    v_mul_f32 v98, s34, v98
    v_mul_f32 v99, s34, v99
    v_mul_f32 v100, s34, v100
    v_mul_f32 v101, s34, v101
    v_mul_f32 v102, s34, v102
    v_mul_f32 v103, s34, v103
    v_cvt_pk_bf16_f32 v16, v96, v97
    v_cvt_pk_bf16_f32 v17, v98, v99
    v_cvt_pk_bf16_f32 v18, v100, v101
    v_cvt_pk_bf16_f32 v19, v102, v103
    v_dot2_f32_bf16 v40, v16, v16, v40
    v_dot2_f32_bf16 v41, v17, v17, v41
    v_dot2_f32_bf16 v42, v18, v18, v42
    v_dot2_f32_bf16 v43, v19, v19, v43
    s_waitcnt vmcnt(4)
    v_lshlrev_b32 v96, 16, v20
    v_and_b32 v97, 0xffff0000, v20
    v_lshlrev_b32 v98, 16, v21
    v_and_b32 v99, 0xffff0000, v21
    v_lshlrev_b32 v100, 16, v22
    v_and_b32 v101, 0xffff0000, v22
    v_lshlrev_b32 v102, 16, v23
    v_and_b32 v103, 0xffff0000, v23
    v_mul_f32 v96, s34, v96
    v_mul_f32 v97, s34, v97
    v_mul_f32 v98, s34, v98
    v_mul_f32 v99, s34, v99
    v_mul_f32 v100, s34, v100
    v_mul_f32 v101, s34, v101
    v_mul_f32 v102, s34, v102
    v_mul_f32 v103, s34, v103
    v_cvt_pk_bf16_f32 v20, v96, v97
    v_cvt_pk_bf16_f32 v21, v98, v99
    v_cvt_pk_bf16_f32 v22, v100, v101
    v_cvt_pk_bf16_f32 v23, v102, v103
    v_dot2_f32_bf16 v40, v20, v20, v40
    v_dot2_f32_bf16 v41, v21, v21, v41
    v_dot2_f32_bf16 v42, v22, v22, v42
    v_dot2_f32_bf16 v43, v23, v23, v43
    s_waitcnt vmcnt(3)
    v_lshlrev_b32 v96, 16, v24
    v_and_b32 v97, 0xffff0000, v24
    v_lshlrev_b32 v98, 16, v25
    v_and_b32 v99, 0xffff0000, v25
    v_lshlrev_b32 v100, 16, v26
    v_and_b32 v101, 0xffff0000, v26
    v_lshlrev_b32 v102, 16, v27
    v_and_b32 v103, 0xffff0000, v27
    v_mul_f32 v96, s34, v96
    v_mul_f32 v97, s34, v97
    v_mul_f32 v98, s34, v98
    v_mul_f32 v99, s34, v99
    v_mul_f32 v100, s34, v100
    v_mul_f32 v101, s34, v101
    v_mul_f32 v102, s34, v102
    v_mul_f32 v103, s34, v103
    v_cvt_pk_bf16_f32 v24, v96, v97
    v_cvt_pk_bf16_f32 v25, v98, v99
    v_cvt_pk_bf16_f32 v26, v100, v101
    v_cvt_pk_bf16_f32 v27, v102, v103
    v_dot2_f32_bf16 v40, v24, v24, v40
    v_dot2_f32_bf16 v41, v25, v25, v41
    v_dot2_f32_bf16 v42, v26, v26, v42
    v_dot2_f32_bf16 v43, v27, v27, v43
    s_waitcnt vmcnt(2)
    v_lshlrev_b32 v96, 16, v28
    v_and_b32 v97, 0xffff0000, v28
    v_lshlrev_b32 v98, 16, v29
    v_and_b32 v99, 0xffff0000, v29
    v_lshlrev_b32 v100, 16, v30
    v_and_b32 v101, 0xffff0000, v30
    v_lshlrev_b32 v102, 16, v31
    v_and_b32 v103, 0xffff0000, v31
    v_mul_f32 v96, s34, v96
    v_mul_f32 v97, s34, v97
    v_mul_f32 v98, s34, v98
    v_mul_f32 v99, s34, v99
    v_mul_f32 v100, s34, v100
    v_mul_f32 v101, s34, v101
    v_mul_f32 v102, s34, v102
    v_mul_f32 v103, s34, v103
    v_cvt_pk_bf16_f32 v28, v96, v97
    v_cvt_pk_bf16_f32 v29, v98, v99
    v_cvt_pk_bf16_f32 v30, v100, v101
    v_cvt_pk_bf16_f32 v31, v102, v103
    v_dot2_f32_bf16 v40, v28, v28, v40
    v_dot2_f32_bf16 v41, v29, v29, v41
    v_dot2_f32_bf16 v42, v30, v30, v42
    v_dot2_f32_bf16 v43, v31, v31, v43
    s_waitcnt vmcnt(1)
    v_lshlrev_b32 v96, 16, v32
    v_and_b32 v97, 0xffff0000, v32
    v_lshlrev_b32 v98, 16, v33
    v_and_b32 v99, 0xffff0000, v33
    v_lshlrev_b32 v100, 16, v34
    v_and_b32 v101, 0xffff0000, v34
    v_lshlrev_b32 v102, 16, v35
    v_and_b32 v103, 0xffff0000, v35
    v_mul_f32 v96, s34, v96
    v_mul_f32 v97, s34, v97
    v_mul_f32 v98, s34, v98
    v_mul_f32 v99, s34, v99
    v_mul_f32 v100, s34, v100
    v_mul_f32 v101, s34, v101
    v_mul_f32 v102, s34, v102
    v_mul_f32 v103, s34, v103
    v_cvt_pk_bf16_f32 v32, v96, v97
    v_cvt_pk_bf16_f32 v33, v98, v99
    v_cvt_pk_bf16_f32 v34, v100, v101
    v_cvt_pk_bf16_f32 v35, v102, v103
    v_dot2_f32_bf16 v40, v32, v32, v40
    v_dot2_f32_bf16 v41, v33, v33, v41
    v_dot2_f32_bf16 v42, v34, v34, v42
    v_dot2_f32_bf16 v43, v35, v35, v43
    s_waitcnt vmcnt(0)
    v_lshlrev_b32 v96, 16, v36
    v_and_b32 v97, 0xffff0000, v36
    v_lshlrev_b32 v98, 16, v37
    v_and_b32 v99, 0xffff0000, v37
    v_lshlrev_b32 v100, 16, v38
    v_and_b32 v101, 0xffff0000, v38
    v_lshlrev_b32 v102, 16, v39
    v_and_b32 v103, 0xffff0000, v39
    v_mul_f32 v96, s34, v96
    v_mul_f32 v97, s34, v97
    v_mul_f32 v98, s34, v98
    v_mul_f32 v99, s34, v99
    v_mul_f32 v100, s34, v100
    v_mul_f32 v101, s34, v101
    v_mul_f32 v102, s34, v102
    v_mul_f32 v103, s34, v103
    v_cvt_pk_bf16_f32 v36, v96, v97
    v_cvt_pk_bf16_f32 v37, v98, v99
    v_cvt_pk_bf16_f32 v38, v100, v101
    v_cvt_pk_bf16_f32 v39, v102, v103
    v_dot2_f32_bf16 v40, v36, v36, v40
    v_dot2_f32_bf16 v41, v37, v37, v41
    v_dot2_f32_bf16 v42, v38, v38, v42
    v_dot2_f32_bf16 v43, v39, v39, v43
    s_nop 3
    v_add_f32 v40, v40, v41
    v_add_f32 v42, v42, v43
    v_add_f32 v40, v40, v42
    v_mov_b32 v41, v40
    s_nop 1
    v_permlane32_swap_b32 v40, v41
    v_add_f32 v40, v40, v41
    v_mov_b32 v41, v40
    s_nop 1
    v_permlane16_swap_b32 v40, v41
    v_add_f32 v40, v40, v41
    v_cvt_pk_bf16_f32 v41, v40, v40
    v_lshlrev_b32 v44, 16, v41
    s_mul_i32 s41, s28, 6144
    s_add_u32 s41, s41, 58368
    s_add_u32 s32, s41, 0
    s_mov_b32 m0, s32
    s_nop 0
    buffer_load_dwordx4 v3, s[16:19], s31 offen offset:0 nt lds
    buffer_load_dwordx4 v3, s[16:19], s31 offen offset:3072 nt lds
    s_add_u32 s32, s41, 1024
    s_mov_b32 m0, s32
    s_nop 0
    buffer_load_dwordx4 v4, s[16:19], s31 offen offset:0 nt lds
    buffer_load_dwordx4 v4, s[16:19], s31 offen offset:3072 nt lds
    s_add_u32 s32, s41, 2048
    s_mov_b32 m0, s32
    s_nop 0
    buffer_load_dwordx4 v5, s[16:19], s31 offen offset:0 nt lds
    buffer_load_dwordx4 v5, s[16:19], s31 offen offset:3072 nt lds
    ds_read_b128 v[64:67], v11 offset:0
    ds_read_b128 v[68:71], v11 offset:1024
    ds_read_b128 v[72:75], v11 offset:2048
    ds_read_b128 v[76:79], v11 offset:3072
    s_waitcnt lgkmcnt(3)
    v_mfma_f32_16x16x32_bf16 v[48:51], v[64:67], v[16:19], 0
    ds_read_b128 v[64:67], v11 offset:4096
    s_waitcnt lgkmcnt(3)
    v_mfma_f32_16x16x32_bf16 v[48:51], v[68:71], v[20:23], v[48:51]
    ds_read_b128 v[68:71], v11 offset:5120
    s_waitcnt lgkmcnt(3)
    v_mfma_f32_16x16x32_bf16 v[48:51], v[72:75], v[24:27], v[48:51]
    ds_read_b128 v[72:75], v11 offset:6144
    s_waitcnt lgkmcnt(3)
    v_mfma_f32_16x16x32_bf16 v[48:51], v[76:79], v[28:31], v[48:51]
    ds_read_b128 v[76:79], v11 offset:7168
    s_waitcnt lgkmcnt(3)
    v_mfma_f32_16x16x32_bf16 v[48:51], v[64:67], v[32:35], v[48:51]
    ds_read_b128 v[64:67], v11 offset:8192
    s_waitcnt lgkmcnt(3)
    v_mfma_f32_16x16x32_bf16 v[48:51], v[68:71], v[36:39], v[48:51]
    ds_read_b128 v[68:71], v11 offset:9216
    s_waitcnt lgkmcnt(3)
    v_mfma_f32_16x16x32_bf16 v[52:55], v[72:75], v[16:19], 0
    ds_read_b128 v[72:75], v11 offset:10240
    s_waitcnt lgkmcnt(3)
    v_mfma_f32_16x16x32_bf16 v[52:55], v[76:79], v[20:23], v[52:55]
    ds_read_b128 v[76:79], v11 offset:11264
    s_waitcnt lgkmcnt(3)
    v_mfma_f32_16x16x32_bf16 v[52:55], v[64:67], v[24:27], v[52:55]
    ds_read_b128 v[64:67], v11 offset:12288
    s_waitcnt lgkmcnt(3)
    v_mfma_f32_16x16x32_bf16 v[52:55], v[68:71], v[28:31], v[52:55]
    ds_read_b128 v[68:71], v11 offset:13312
    s_waitcnt lgkmcnt(3)
    v_mfma_f32_16x16x32_bf16 v[52:55], v[72:75], v[32:35], v[52:55]
    ds_read_b128 v[72:75], v11 offset:14336
    s_waitcnt lgkmcnt(3)
    v_mfma_f32_16x16x32_bf16 v[52:55], v[76:79], v[36:39], v[52:55]
    ds_read_b128 v[76:79], v11 offset:15360
    s_waitcnt lgkmcnt(3)
    v_mfma_f32_16x16x32_bf16 v[56:59], v[64:67], v[16:19], 0
    ds_read_b128 v[64:67], v11 offset:16384
    s_waitcnt lgkmcnt(3)
    v_mfma_f32_16x16x32_bf16 v[56:59], v[68:71], v[20:23], v[56:59]
    ds_read_b128 v[68:71], v11 offset:17408
    s_waitcnt lgkmcnt(3)
    v_mfma_f32_16x16x32_bf16 v[56:59], v[72:75], v[24:27], v[56:59]
    ds_read_b128 v[72:75], v11 offset:18432
    s_waitcnt lgkmcnt(3)
    v_mfma_f32_16x16x32_bf16 v[56:59], v[76:79], v[28:31], v[56:59]
    ds_read_b128 v[76:79], v11 offset:19456
    s_waitcnt lgkmcnt(3)
    v_mfma_f32_16x16x32_bf16 v[56:59], v[64:67], v[32:35], v[56:59]
    ds_read_b128 v[64:67], v11 offset:20480
    s_waitcnt lgkmcnt(3)
    v_mfma_f32_16x16x32_bf16 v[56:59], v[68:71], v[36:39], v[56:59]
    ds_read_b128 v[68:71], v11 offset:21504
    s_waitcnt lgkmcnt(3)
    v_mfma_f32_16x16x32_bf16 v[60:63], v[72:75], v[16:19], 0
    ds_read_b128 v[72:75], v11 offset:22528
    s_waitcnt lgkmcnt(3)
    v_mfma_f32_16x16x32_bf16 v[60:63], v[76:79], v[20:23], v[60:63]
    ds_read_b128 v[76:79], v11 offset:23552
    s_waitcnt lgkmcnt(3)
    v_mfma_f32_16x16x32_bf16 v[60:63], v[64:67], v[24:27], v[60:63]
    s_waitcnt lgkmcnt(2)
    v_mfma_f32_16x16x32_bf16 v[60:63], v[68:71], v[28:31], v[60:63]
    s_waitcnt lgkmcnt(1)
    v_mfma_f32_16x16x32_bf16 v[60:63], v[72:75], v[32:35], v[60:63]
    s_waitcnt lgkmcnt(0)
    v_mfma_f32_16x16x32_bf16 v[60:63], v[76:79], v[36:39], v[60:63]
    v_cvt_pk_bf16_f32 v80, v48, v49
    v_cvt_pk_bf16_f32 v81, v50, v51
    v_lshlrev_b32 v82, 16, v80
    v_and_b32 v83, 0xffff0000, v80
    v_lshlrev_b32 v84, 16, v81
    v_and_b32 v85, 0xffff0000, v81
    v_fma_f32 v82, v44, -0.5, v82
    v_fma_f32 v83, v44, -0.5, v83
    v_fma_f32 v84, v44, -0.5, v84
    v_fma_f32 v85, v44, -0.5, v85
    v_cvt_pk_bf16_f32 v80, v82, v83
    v_cvt_pk_bf16_f32 v81, v84, v85
    v_lshlrev_b32 v82, 16, v80
    v_and_b32 v83, 0xffff0000, v80
    v_lshlrev_b32 v84, 16, v81
    v_and_b32 v85, 0xffff0000, v81
    v_mul_f32 v86, s35, v82
    v_mul_f32 v87, s35, v83
    v_mul_f32 v88, s35, v84
    v_mul_f32 v89, s35, v85
    v_fma_f32 v90, v82, s35, -v86
    v_fma_f32 v91, v83, s35, -v87
    v_fma_f32 v92, v84, s35, -v88
    v_fma_f32 v93, v85, s35, -v89
    v_fma_f32 v90, v82, s36, v90
    v_fma_f32 v91, v83, s36, v91
    v_fma_f32 v92, v84, s36, v92
    v_fma_f32 v93, v85, s36, v93
    v_exp_f32 v86, v86
    v_exp_f32 v87, v87
    v_exp_f32 v88, v88
    v_exp_f32 v89, v89
    v_mul_f32 v90, s37, v90
    v_mul_f32 v91, s37, v91
    v_mul_f32 v92, s37, v92
    v_mul_f32 v93, s37, v93
    v_fma_f32 v86, v86, v90, v86
    v_fma_f32 v87, v87, v91, v87
    v_fma_f32 v88, v88, v92, v88
    v_fma_f32 v89, v89, v93, v89
    v_cvt_pk_bf16_f32 v80, v86, v87
    v_cvt_pk_bf16_f32 v81, v88, v89
    v_lshlrev_b32 v82, 16, v80
    v_and_b32 v83, 0xffff0000, v80
    v_lshlrev_b32 v84, 16, v81
    v_and_b32 v85, 0xffff0000, v81
    v_fma_f32 v82, v82, v45, v46
    v_fma_f32 v83, v83, v45, v46
    v_fma_f32 v84, v84, v45, v46
    v_fma_f32 v85, v85, v45, v46
    v_cvt_pk_bf16_f32 v96, v82, v83
    v_cvt_pk_bf16_f32 v97, v84, v85
    ds_write_b64 v6, v[96:97] offset:0
    v_cvt_pk_bf16_f32 v80, v52, v53
    v_cvt_pk_bf16_f32 v81, v54, v55
    v_lshlrev_b32 v82, 16, v80
    v_and_b32 v83, 0xffff0000, v80
    v_lshlrev_b32 v84, 16, v81
    v_and_b32 v85, 0xffff0000, v81
    v_fma_f32 v82, v44, -0.5, v82
    v_fma_f32 v83, v44, -0.5, v83
    v_fma_f32 v84, v44, -0.5, v84
    v_fma_f32 v85, v44, -0.5, v85
    v_cvt_pk_bf16_f32 v80, v82, v83
    v_cvt_pk_bf16_f32 v81, v84, v85
    v_lshlrev_b32 v82, 16, v80
    v_and_b32 v83, 0xffff0000, v80
    v_lshlrev_b32 v84, 16, v81
    v_and_b32 v85, 0xffff0000, v81
    v_mul_f32 v86, s35, v82
    v_mul_f32 v87, s35, v83
    v_mul_f32 v88, s35, v84
    v_mul_f32 v89, s35, v85
    v_fma_f32 v90, v82, s35, -v86
    v_fma_f32 v91, v83, s35, -v87
    v_fma_f32 v92, v84, s35, -v88
    v_fma_f32 v93, v85, s35, -v89
    v_fma_f32 v90, v82, s36, v90
    v_fma_f32 v91, v83, s36, v91
    v_fma_f32 v92, v84, s36, v92
    v_fma_f32 v93, v85, s36, v93
    v_exp_f32 v86, v86
    v_exp_f32 v87, v87
    v_exp_f32 v88, v88
    v_exp_f32 v89, v89
    v_mul_f32 v90, s37, v90
    v_mul_f32 v91, s37, v91
    v_mul_f32 v92, s37, v92
    v_mul_f32 v93, s37, v93
    v_fma_f32 v86, v86, v90, v86
    v_fma_f32 v87, v87, v91, v87
    v_fma_f32 v88, v88, v92, v88
    v_fma_f32 v89, v89, v93, v89
    v_cvt_pk_bf16_f32 v80, v86, v87
    v_cvt_pk_bf16_f32 v81, v88, v89
    v_lshlrev_b32 v82, 16, v80
    v_and_b32 v83, 0xffff0000, v80
    v_lshlrev_b32 v84, 16, v81
    v_and_b32 v85, 0xffff0000, v81
    v_fma_f32 v82, v82, v45, v46
    v_fma_f32 v83, v83, v45, v46
    v_fma_f32 v84, v84, v45, v46
    v_fma_f32 v85, v85, v45, v46
    v_cvt_pk_bf16_f32 v98, v82, v83
    v_cvt_pk_bf16_f32 v99, v84, v85
    ds_write_b64 v6, v[98:99] offset:8448
    v_cvt_pk_bf16_f32 v80, v56, v57
    v_cvt_pk_bf16_f32 v81, v58, v59
    v_lshlrev_b32 v82, 16, v80
    v_and_b32 v83, 0xffff0000, v80
    v_lshlrev_b32 v84, 16, v81
    v_and_b32 v85, 0xffff0000, v81
    v_fma_f32 v82, v44, -0.5, v82
    v_fma_f32 v83, v44, -0.5, v83
    v_fma_f32 v84, v44, -0.5, v84
    v_fma_f32 v85, v44, -0.5, v85
    v_cvt_pk_bf16_f32 v80, v82, v83
    v_cvt_pk_bf16_f32 v81, v84, v85
    v_lshlrev_b32 v82, 16, v80
    v_and_b32 v83, 0xffff0000, v80
    v_lshlrev_b32 v84, 16, v81
    v_and_b32 v85, 0xffff0000, v81
    v_mul_f32 v86, s35, v82
    v_mul_f32 v87, s35, v83
    v_mul_f32 v88, s35, v84
    v_mul_f32 v89, s35, v85
    v_fma_f32 v90, v82, s35, -v86
    v_fma_f32 v91, v83, s35, -v87
    v_fma_f32 v92, v84, s35, -v88
    v_fma_f32 v93, v85, s35, -v89
    v_fma_f32 v90, v82, s36, v90
    v_fma_f32 v91, v83, s36, v91
    v_fma_f32 v92, v84, s36, v92
    v_fma_f32 v93, v85, s36, v93
    v_exp_f32 v86, v86
    v_exp_f32 v87, v87
    v_exp_f32 v88, v88
    v_exp_f32 v89, v89
    v_mul_f32 v90, s37, v90
    v_mul_f32 v91, s37, v91
    v_mul_f32 v92, s37, v92
    v_mul_f32 v93, s37, v93
    v_fma_f32 v86, v86, v90, v86
    v_fma_f32 v87, v87, v91, v87
    v_fma_f32 v88, v88, v92, v88
    v_fma_f32 v89, v89, v93, v89
    v_cvt_pk_bf16_f32 v80, v86, v87
    v_cvt_pk_bf16_f32 v81, v88, v89
    v_lshlrev_b32 v82, 16, v80
    v_and_b32 v83, 0xffff0000, v80
    v_lshlrev_b32 v84, 16, v81
    v_and_b32 v85, 0xffff0000, v81
    v_fma_f32 v82, v82, v45, v46
    v_fma_f32 v83, v83, v45, v46
    v_fma_f32 v84, v84, v45, v46
    v_fma_f32 v85, v85, v45, v46
    v_cvt_pk_bf16_f32 v100, v82, v83
    v_cvt_pk_bf16_f32 v101, v84, v85
    ds_write_b64 v6, v[100:101] offset:16896
    v_cvt_pk_bf16_f32 v80, v60, v61
    v_cvt_pk_bf16_f32 v81, v62, v63
    v_lshlrev_b32 v82, 16, v80
    v_and_b32 v83, 0xffff0000, v80
    v_lshlrev_b32 v84, 16, v81
    v_and_b32 v85, 0xffff0000, v81
    v_fma_f32 v82, v44, -0.5, v82
    v_fma_f32 v83, v44, -0.5, v83
    v_fma_f32 v84, v44, -0.5, v84
    v_fma_f32 v85, v44, -0.5, v85
    v_cvt_pk_bf16_f32 v80, v82, v83
    v_cvt_pk_bf16_f32 v81, v84, v85
    v_lshlrev_b32 v82, 16, v80
    v_and_b32 v83, 0xffff0000, v80
    v_lshlrev_b32 v84, 16, v81
    v_and_b32 v85, 0xffff0000, v81
    v_mul_f32 v86, s35, v82
    v_mul_f32 v87, s35, v83
    v_mul_f32 v88, s35, v84
    v_mul_f32 v89, s35, v85
    v_fma_f32 v90, v82, s35, -v86
    v_fma_f32 v91, v83, s35, -v87
    v_fma_f32 v92, v84, s35, -v88
    v_fma_f32 v93, v85, s35, -v89
    v_fma_f32 v90, v82, s36, v90
    v_fma_f32 v91, v83, s36, v91
    v_fma_f32 v92, v84, s36, v92
    v_fma_f32 v93, v85, s36, v93
    v_exp_f32 v86, v86
    v_exp_f32 v87, v87
    v_exp_f32 v88, v88
    v_exp_f32 v89, v89
    v_mul_f32 v90, s37, v90
    v_mul_f32 v91, s37, v91
    v_mul_f32 v92, s37, v92
    v_mul_f32 v93, s37, v93
    v_fma_f32 v86, v86, v90, v86
    v_fma_f32 v87, v87, v91, v87
    v_fma_f32 v88, v88, v92, v88
    v_fma_f32 v89, v89, v93, v89
    v_cvt_pk_bf16_f32 v80, v86, v87
    v_cvt_pk_bf16_f32 v81, v88, v89
    v_lshlrev_b32 v82, 16, v80
    v_and_b32 v83, 0xffff0000, v80
    v_lshlrev_b32 v84, 16, v81
    v_and_b32 v85, 0xffff0000, v81
    v_fma_f32 v82, v82, v45, v46
    v_fma_f32 v83, v83, v45, v46
    v_fma_f32 v84, v84, v45, v46
    v_fma_f32 v85, v85, v45, v46
    v_cvt_pk_bf16_f32 v102, v82, v83
    v_cvt_pk_bf16_f32 v103, v84, v85
    ds_write_b64 v6, v[102:103] offset:25344
    s_waitcnt vmcnt(0) lgkmcnt(0)
    s_barrier
    v_mov_b32 v72, 0x3f803f80
    v_mov_b32 v73, 0x3f803f80
    v_mov_b32 v74, 0x3f803f80
    v_mov_b32 v75, 0x3f803f80
    ds_read_b64_tr_b16 v[64:65], v7 offset:0
    ds_read_b64_tr_b16 v[66:67], v7 offset:128
    ds_read_b64_tr_b16 v[16:17], v8 offset:0
    ds_read_b64_tr_b16 v[18:19], v8 offset:6144
    ds_read_b64_tr_b16 v[20:21], v9 offset:0
    ds_read_b64_tr_b16 v[22:23], v9 offset:6144
    ds_read_b64_tr_b16 v[24:25], v10 offset:0
    ds_read_b64_tr_b16 v[26:27], v10 offset:6144
    ds_read_b64_tr_b16 v[68:69], v7 offset:256
    ds_read_b64_tr_b16 v[70:71], v7 offset:384
    ds_read_b64_tr_b16 v[28:29], v8 offset:12288
    ds_read_b64_tr_b16 v[30:31], v8 offset:18432
    ds_read_b64_tr_b16 v[32:33], v9 offset:12288
    ds_read_b64_tr_b16 v[34:35], v9 offset:18432
    ds_read_b64_tr_b16 v[36:37], v10 offset:12288
    ds_read_b64_tr_b16 v[38:39], v10 offset:18432
    s_waitcnt lgkmcnt(8)
    v_mfma_f32_16x16x32_bf16 v[48:51], v[64:67], v[16:19], 0
    v_mfma_f32_16x16x32_bf16 v[52:55], v[64:67], v[20:23], 0
    v_mfma_f32_16x16x32_bf16 v[56:59], v[64:67], v[24:27], 0
    v_mfma_f32_16x16x32_bf16 v[60:63], v[64:67], v[72:75], 0
    ds_read_b64_tr_b16 v[64:65], v7 offset:512
    ds_read_b64_tr_b16 v[66:67], v7 offset:640
    ds_read_b64_tr_b16 v[16:17], v8 offset:24576
    ds_read_b64_tr_b16 v[18:19], v8 offset:30720
    ds_read_b64_tr_b16 v[20:21], v9 offset:24576
    ds_read_b64_tr_b16 v[22:23], v9 offset:30720
    ds_read_b64_tr_b16 v[24:25], v10 offset:24576
    ds_read_b64_tr_b16 v[26:27], v10 offset:30720
    s_waitcnt lgkmcnt(8)
    v_mfma_f32_16x16x32_bf16 v[48:51], v[68:71], v[28:31], v[48:51]
    v_mfma_f32_16x16x32_bf16 v[52:55], v[68:71], v[32:35], v[52:55]
    v_mfma_f32_16x16x32_bf16 v[56:59], v[68:71], v[36:39], v[56:59]
    v_mfma_f32_16x16x32_bf16 v[60:63], v[68:71], v[72:75], v[60:63]
    ds_read_b64_tr_b16 v[68:69], v7 offset:768
    ds_read_b64_tr_b16 v[70:71], v7 offset:896
    ds_read_b64_tr_b16 v[28:29], v8 offset:36864
    ds_read_b64_tr_b16 v[30:31], v8 offset:43008
    ds_read_b64_tr_b16 v[32:33], v9 offset:36864
    ds_read_b64_tr_b16 v[34:35], v9 offset:43008
    ds_read_b64_tr_b16 v[36:37], v10 offset:36864
    ds_read_b64_tr_b16 v[38:39], v10 offset:43008
    s_waitcnt lgkmcnt(8)
    v_mfma_f32_16x16x32_bf16 v[48:51], v[64:67], v[16:19], v[48:51]
    v_mfma_f32_16x16x32_bf16 v[52:55], v[64:67], v[20:23], v[52:55]
    v_mfma_f32_16x16x32_bf16 v[56:59], v[64:67], v[24:27], v[56:59]
    v_mfma_f32_16x16x32_bf16 v[60:63], v[64:67], v[72:75], v[60:63]
    v_add_u32 v8, 49152, v8
    v_add_u32 v9, 49152, v9
    v_add_u32 v10, 49152, v10
    ds_read_b64_tr_b16 v[64:65], v7 offset:1024
    ds_read_b64_tr_b16 v[66:67], v7 offset:1152
    ds_read_b64_tr_b16 v[16:17], v8 offset:0
    ds_read_b64_tr_b16 v[18:19], v8 offset:6144
    ds_read_b64_tr_b16 v[20:21], v9 offset:0
    ds_read_b64_tr_b16 v[22:23], v9 offset:6144
    ds_read_b64_tr_b16 v[24:25], v10 offset:0
    ds_read_b64_tr_b16 v[26:27], v10 offset:6144
    s_waitcnt lgkmcnt(8)
    v_mfma_f32_16x16x32_bf16 v[48:51], v[68:71], v[28:31], v[48:51]
    v_mfma_f32_16x16x32_bf16 v[52:55], v[68:71], v[32:35], v[52:55]
    v_mfma_f32_16x16x32_bf16 v[56:59], v[68:71], v[36:39], v[56:59]
    v_mfma_f32_16x16x32_bf16 v[60:63], v[68:71], v[72:75], v[60:63]
    ds_read_b64_tr_b16 v[68:69], v7 offset:1280
    ds_read_b64_tr_b16 v[70:71], v7 offset:1408
    ds_read_b64_tr_b16 v[28:29], v8 offset:12288
    ds_read_b64_tr_b16 v[30:31], v8 offset:18432
    ds_read_b64_tr_b16 v[32:33], v9 offset:12288
    ds_read_b64_tr_b16 v[34:35], v9 offset:18432
    ds_read_b64_tr_b16 v[36:37], v10 offset:12288
    ds_read_b64_tr_b16 v[38:39], v10 offset:18432
    s_waitcnt lgkmcnt(8)
    v_mfma_f32_16x16x32_bf16 v[48:51], v[64:67], v[16:19], v[48:51]
    v_mfma_f32_16x16x32_bf16 v[52:55], v[64:67], v[20:23], v[52:55]
    v_mfma_f32_16x16x32_bf16 v[56:59], v[64:67], v[24:27], v[56:59]
    v_mfma_f32_16x16x32_bf16 v[60:63], v[64:67], v[72:75], v[60:63]
    ds_read_b64_tr_b16 v[64:65], v7 offset:1536
    ds_read_b64_tr_b16 v[66:67], v7 offset:1664
    ds_read_b64_tr_b16 v[16:17], v8 offset:24576
    ds_read_b64_tr_b16 v[18:19], v8 offset:30720
    ds_read_b64_tr_b16 v[20:21], v9 offset:24576
    ds_read_b64_tr_b16 v[22:23], v9 offset:30720
    ds_read_b64_tr_b16 v[24:25], v10 offset:24576
    ds_read_b64_tr_b16 v[26:27], v10 offset:30720
    s_waitcnt lgkmcnt(8)
    v_mfma_f32_16x16x32_bf16 v[48:51], v[68:71], v[28:31], v[48:51]
    v_mfma_f32_16x16x32_bf16 v[52:55], v[68:71], v[32:35], v[52:55]
    v_mfma_f32_16x16x32_bf16 v[56:59], v[68:71], v[36:39], v[56:59]
    v_mfma_f32_16x16x32_bf16 v[60:63], v[68:71], v[72:75], v[60:63]
    ds_read_b64_tr_b16 v[68:69], v7 offset:1792
    ds_read_b64_tr_b16 v[70:71], v7 offset:1920
    ds_read_b64_tr_b16 v[28:29], v8 offset:36864
    ds_read_b64_tr_b16 v[30:31], v8 offset:43008
    ds_read_b64_tr_b16 v[32:33], v9 offset:36864
    ds_read_b64_tr_b16 v[34:35], v9 offset:43008
    ds_read_b64_tr_b16 v[36:37], v10 offset:36864
    ds_read_b64_tr_b16 v[38:39], v10 offset:43008
    s_waitcnt lgkmcnt(8)
    v_mfma_f32_16x16x32_bf16 v[48:51], v[64:67], v[16:19], v[48:51]
    v_mfma_f32_16x16x32_bf16 v[52:55], v[64:67], v[20:23], v[52:55]
    v_mfma_f32_16x16x32_bf16 v[56:59], v[64:67], v[24:27], v[56:59]
    v_mfma_f32_16x16x32_bf16 v[60:63], v[64:67], v[72:75], v[60:63]
    s_waitcnt lgkmcnt(0)
    v_mfma_f32_16x16x32_bf16 v[48:51], v[68:71], v[28:31], v[48:51]
    v_mfma_f32_16x16x32_bf16 v[52:55], v[68:71], v[32:35], v[52:55]
    v_mfma_f32_16x16x32_bf16 v[56:59], v[68:71], v[36:39], v[56:59]
    v_mfma_f32_16x16x32_bf16 v[60:63], v[68:71], v[72:75], v[60:63]
    s_nop 7
    s_nop 1
    buffer_store_dwordx4 v[48:51], v11, s[24:27], s40 offen offset:0
    buffer_store_dwordx4 v[52:55], v11, s[24:27], s40 offen offset:1024
    buffer_store_dwordx4 v[56:59], v11, s[24:27], s40 offen offset:2048
    s_cmp_lg_u32 s39, 0
    s_cbranch_scc1 L_p1_noz
    s_mul_i32 s32, s2, 52
    s_mul_i32 s33, s38, 13
    s_add_u32 s32, s32, s33
    s_add_u32 s32, s32, 12
    s_lshl_b32 s32, s32, 10
    buffer_store_dwordx4 v[60:63], v11, s[24:27], s32 offen
L_p1_noz:
    s_or_b32 s32, s30, s28
    s_cmp_lg_u32 s32, 0
    s_cbranch_scc1 L_p1_nocnt
    s_lshl_b32 s32, s29, 8
    s_add_u32 s32, s32, 17825792
    v_mov_b32 v12, 0
    v_mov_b32 v13, 0
    s_mov_b64 exec, 1
    s_nop 1
    buffer_store_dword v12, v13, s[24:27], s32 offen
    s_mov_b64 exec, -1
L_p1_nocnt:
L_p1_end:
    s_endpgm
.globl standalone__linear_kernel_rfa__prompt_kernel
.p2align 8
.type standalone__linear_kernel_rfa__prompt_kernel,@function
standalone__linear_kernel_rfa__prompt_kernel:
    s_cmp_ge_u32 s2, 256
    s_cbranch_scc1 L_p2_end
    s_load_dwordx2 s[4:5], s[0:1], 0
    s_load_dwordx2 s[6:7], s[0:1], 32
    s_load_dwordx2 s[8:9], s[0:1], 24
    s_load_dwordx2 s[10:11], s[0:1], 48
    v_and_b32 v1, 63, v0
    v_lshrrev_b32 v12, 6, v0
    v_and_b32 v13, 15, v1
    v_readfirstlane_b32 s28, v12
    v_lshrrev_b32 v14, 4, v1
    v_mul_u32_u24 v2, 384, v13
    v_lshl_add_u32 v2, v14, 4, v2
    v_lshlrev_b32 v11, 4, v1
    s_lshr_b32 s29, s2, 3
    s_and_b32 s30, s2, 7
    s_mov_b32 s34, 0x3e898b82
    s_mov_b32 s35, 0x3fb8aa3b
    s_mov_b32 s36, 0x32a57060
    s_mov_b32 s37, 0x3f317218
    v_mov_b32 v45, 0x3e000000
    v_mov_b32 v46, 0x35860000
    s_lshl_b32 s32, s29, 11
    s_lshl_b32 s33, s30, 8
    s_add_u32 s32, s32, s33
    s_lshl_b32 s33, s28, 4
    s_add_u32 s32, s32, s33
    s_mul_i32 s31, s32, 384
    s_waitcnt lgkmcnt(0)
    s_mov_b32 s12, s4
    s_mov_b32 s13, s5
    s_mov_b32 s14, 25165824
    s_mov_b32 s15, 0x00020000
    s_mov_b32 s16, s6
    s_mov_b32 s17, s7
    s_mov_b32 s18, 25165824
    s_mov_b32 s19, 0x00020000
    s_mov_b32 s20, s8
    s_mov_b32 s21, s9
    s_mov_b32 s22, 24576
    s_mov_b32 s23, 0x00020000
    s_mov_b32 s24, s10
    s_mov_b32 s25, s11
    s_mov_b32 s26, 17833984
    s_mov_b32 s27, 0x00020000
    v_mov_b32 v6, 51200
    v_mov_b32 v100, 0
    v_mov_b32 v101, 0
    v_mov_b32 v102, 0
    v_mov_b32 v103, 0
    ds_write_b128 v6, v[100:103]
    ds_write_b32 v6, v100 offset:16
    ds_write_b32 v6, v100 offset:20
    s_mov_b32 s41, s28
    s_mul_i32 s32, s41, 43
    s_lshr_b32 s32, s32, 8
    s_mul_i32 s33, s32, 6
    s_sub_u32 s33, s41, s33
    s_mul_i32 s32, s32, 6144
    s_lshl_b32 s33, s33, 6
    s_add_u32 s32, s32, s33
    s_lshl_b32 s33, s41, 10
    s_add_u32 s33, s33, 0
    s_mov_b32 m0, s33
    s_nop 0
    buffer_load_dwordx4 v2, s[20:23], s32 offen lds
    s_cmp_ge_u32 s28, 8
    s_cbranch_scc1 L_om_skip_p2
    s_add_u32 s41, s28, 16
    s_mul_i32 s32, s41, 43
    s_lshr_b32 s32, s32, 8
    s_mul_i32 s33, s32, 6
    s_sub_u32 s33, s41, s33
    s_mul_i32 s32, s32, 6144
    s_lshl_b32 s33, s33, 6
    s_add_u32 s32, s32, s33
    s_lshl_b32 s33, s41, 10
    s_add_u32 s33, s33, 0
    s_mov_b32 m0, s33
    s_nop 0
    buffer_load_dwordx4 v2, s[20:23], s32 offen lds
L_om_skip_p2:
    s_mul_i32 s42, s29, 26624
    s_add_u32 s42, s42, 16777216
    s_cmp_lt_u32 s28, 12
    s_cbranch_scc1 L_f_nothelp1
    buffer_load_dwordx4 v[16:19], v2, s[12:15], s31 offen offset:0 nt
    buffer_load_dwordx4 v[20:23], v2, s[12:15], s31 offen offset:64 nt
    buffer_load_dwordx4 v[24:27], v2, s[12:15], s31 offen offset:128 nt
    buffer_load_dwordx4 v[28:31], v2, s[12:15], s31 offen offset:192 nt
    buffer_load_dwordx4 v[32:35], v2, s[12:15], s31 offen offset:256 nt
    buffer_load_dwordx4 v[36:39], v2, s[12:15], s31 offen offset:320 nt
    s_waitcnt vmcnt(6) lgkmcnt(0)
    s_branch L_f_barA
L_f_nothelp1:
    s_lshl_b32 s58, s28, 3
    s_add_u32 s58, s58, s30
    s_cmp_ge_u32 s58, 26
    s_cbranch_scc1 L_f_nored1
    s_cmp_ge_u32 s58, 13
    s_cselect_b32 s32, 13, 0
    s_sub_u32 s33, s58, s32
    s_lshl_b32 s32, s32, 1
    s_add_u32 s32, s32, s33
    s_mul_i32 s59, s29, 416
    s_add_u32 s59, s59, s32
    s_lshl_b32 s59, s59, 10
    s_add_u32 s61, s59, 13312
    buffer_load_dwordx4 v[48:51], v11, s[24:27], s59 offen
    buffer_load_dwordx4 v[16:19], v11, s[24:27], s61 offen
    s_add_u32 s59, s59, 53248
    s_add_u32 s61, s61, 53248
    buffer_load_dwordx4 v[52:55], v11, s[24:27], s59 offen
    buffer_load_dwordx4 v[20:23], v11, s[24:27], s61 offen
    s_add_u32 s59, s59, 53248
    s_add_u32 s61, s61, 53248
    buffer_load_dwordx4 v[56:59], v11, s[24:27], s59 offen
    buffer_load_dwordx4 v[24:27], v11, s[24:27], s61 offen
    s_add_u32 s59, s59, 53248
    s_add_u32 s61, s61, 53248
    buffer_load_dwordx4 v[60:63], v11, s[24:27], s59 offen
    buffer_load_dwordx4 v[28:31], v11, s[24:27], s61 offen
    s_add_u32 s59, s59, 53248
    s_add_u32 s61, s61, 53248
    buffer_load_dwordx4 v[64:67], v11, s[24:27], s59 offen
    buffer_load_dwordx4 v[32:35], v11, s[24:27], s61 offen
    s_add_u32 s59, s59, 53248
    s_add_u32 s61, s61, 53248
    buffer_load_dwordx4 v[68:71], v11, s[24:27], s59 offen
    buffer_load_dwordx4 v[36:39], v11, s[24:27], s61 offen
    s_add_u32 s59, s59, 53248
    s_add_u32 s61, s61, 53248
    buffer_load_dwordx4 v[72:75], v11, s[24:27], s59 offen
    buffer_load_dwordx4 v[80:83], v11, s[24:27], s61 offen
    s_add_u32 s59, s59, 53248
    s_add_u32 s61, s61, 53248
    buffer_load_dwordx4 v[76:79], v11, s[24:27], s59 offen
    buffer_load_dwordx4 v[84:87], v11, s[24:27], s61 offen
L_f_nored1:
    s_waitcnt vmcnt(0) lgkmcnt(0)
L_f_barA:
    s_barrier
    s_cmp_ge_u32 s28, 12
    s_cbranch_scc1 L_f_front
    s_cmp_ge_u32 s58, 26
    s_cbranch_scc1 L_f_nored2
    s_cmp_ge_u32 s58, 13
    s_cselect_b32 s32, 13, 0
    s_cselect_b32 s41, 1024, 0
    s_sub_u32 s33, s58, s32
    s_add_u32 s60, s42, s41
    v_and_b32 v96, 15, v1
    v_lshrrev_b32 v97, 4, v1
    s_cmp_eq_u32 s33, 12
    s_cbranch_scc1 L_f_ztile
    v_lshrrev_b32 v98, 2, v96
    v_and_b32 v98, 1, v98
    v_lshlrev_b32 v99, 11, v98
    v_lshrrev_b32 v98, 3, v96
    v_lshl_add_u32 v99, v98, 6, v99
    v_and_b32 v98, 3, v96
    v_lshl_add_u32 v99, v98, 4, v99
    v_lshl_add_u32 v99, v97, 8, v99
    s_lshr_b32 s41, s33, 1
    s_lshl_b32 s41, s41, 12
    s_and_b32 s33, s33, 1
    s_lshl_b32 s33, s33, 7
    s_add_u32 s60, s60, s41
    s_add_u32 s60, s60, s33
    s_branch L_f_zdone
L_f_ztile:
    v_lshlrev_b32 v99, 8, v97
    v_lshl_add_u32 v99, v96, 4, v99
    s_add_u32 s60, s60, 24576
L_f_zdone:
    v_add_f32 v48, v48, v52
    v_add_f32 v49, v49, v53
    v_add_f32 v50, v50, v54
    v_add_f32 v51, v51, v55
    v_add_f32 v16, v16, v20
    v_add_f32 v17, v17, v21
    v_add_f32 v18, v18, v22
    v_add_f32 v19, v19, v23
    v_add_f32 v48, v48, v56
    v_add_f32 v49, v49, v57
    v_add_f32 v50, v50, v58
    v_add_f32 v51, v51, v59
    v_add_f32 v16, v16, v24
    v_add_f32 v17, v17, v25
    v_add_f32 v18, v18, v26
    v_add_f32 v19, v19, v27
    v_add_f32 v48, v48, v60
    v_add_f32 v49, v49, v61
    v_add_f32 v50, v50, v62
    v_add_f32 v51, v51, v63
    v_add_f32 v16, v16, v28
    v_add_f32 v17, v17, v29
    v_add_f32 v18, v18, v30
    v_add_f32 v19, v19, v31
    v_add_f32 v48, v48, v64
    v_add_f32 v49, v49, v65
    v_add_f32 v50, v50, v66
    v_add_f32 v51, v51, v67
    v_add_f32 v16, v16, v32
    v_add_f32 v17, v17, v33
    v_add_f32 v18, v18, v34
    v_add_f32 v19, v19, v35
    v_add_f32 v48, v48, v68
    v_add_f32 v49, v49, v69
    v_add_f32 v50, v50, v70
    v_add_f32 v51, v51, v71
    v_add_f32 v16, v16, v36
    v_add_f32 v17, v17, v37
    v_add_f32 v18, v18, v38
    v_add_f32 v19, v19, v39
    v_add_f32 v48, v48, v72
    v_add_f32 v49, v49, v73
    v_add_f32 v50, v50, v74
    v_add_f32 v51, v51, v75
    v_add_f32 v16, v16, v80
    v_add_f32 v17, v17, v81
    v_add_f32 v18, v18, v82
    v_add_f32 v19, v19, v83
    v_add_f32 v48, v48, v76
    v_add_f32 v49, v49, v77
    v_add_f32 v50, v50, v78
    v_add_f32 v51, v51, v79
    v_add_f32 v16, v16, v84
    v_add_f32 v17, v17, v85
    v_add_f32 v18, v18, v86
    v_add_f32 v19, v19, v87
    v_cvt_pk_bf16_f32 v52, v48, v49
    v_cvt_pk_bf16_f32 v53, v50, v51
    v_cvt_pk_bf16_f32 v54, v16, v17
    v_cvt_pk_bf16_f32 v55, v18, v19
    buffer_store_dwordx4 v[52:55], v99, s[24:27], s60 offen sc1
    s_lshl_b32 s32, s29, 8
    s_add_u32 s32, s32, 17825792
    v_mov_b32 v7, s32
    v_mov_b32 v8, 1
    s_waitcnt vmcnt(0)
    v_mov_b32 v96, 1
    s_mov_b64 exec, 1
    s_nop 1
    ds_add_rtn_u32 v97, v6, v96 offset:16
    s_waitcnt lgkmcnt(0)
    s_mov_b64 exec, -1
    v_readfirstlane_b32 s32, v97
    s_cmp_lt_u32 s30, 2
    s_cselect_b32 s33, 3, 2
    s_nop 3
    s_cmp_lg_u32 s32, s33
    s_cbranch_scc1 L_f_nored2
    s_mov_b64 exec, 1
    s_nop 1
    buffer_atomic_add v8, v7, s[24:27], 0 offen sc1
    s_mov_b64 exec, -1
L_f_nored2:
    buffer_load_dwordx4 v[16:19], v2, s[12:15], s31 offen offset:0 nt
    buffer_load_dwordx4 v[20:23], v2, s[12:15], s31 offen offset:64 nt
    buffer_load_dwordx4 v[24:27], v2, s[12:15], s31 offen offset:128 nt
    buffer_load_dwordx4 v[28:31], v2, s[12:15], s31 offen offset:192 nt
    buffer_load_dwordx4 v[32:35], v2, s[12:15], s31 offen offset:256 nt
    buffer_load_dwordx4 v[36:39], v2, s[12:15], s31 offen offset:320 nt
L_f_front:
    v_mov_b32 v40, 0
    v_mov_b32 v41, 0
    v_mov_b32 v42, 0
    v_mov_b32 v43, 0
    s_waitcnt vmcnt(5)
    v_lshlrev_b32 v96, 16, v16
    v_and_b32 v97, 0xffff0000, v16
    v_lshlrev_b32 v98, 16, v17
    v_and_b32 v99, 0xffff0000, v17
    v_lshlrev_b32 v100, 16, v18
    v_and_b32 v101, 0xffff0000, v18
    v_lshlrev_b32 v102, 16, v19
    v_and_b32 v103, 0xffff0000, v19
    v_mul_f32 v96, s34, v96
    v_mul_f32 v97, s34, v97
    v_mul_f32 v98, s34, v98
    v_mul_f32 v99, s34, v99
    v_mul_f32 v100, s34, v100
    v_mul_f32 v101, s34, v101
    v_mul_f32 v102, s34, v102
    v_mul_f32 v103, s34, v103
    v_cvt_pk_bf16_f32 v16, v96, v97
    v_cvt_pk_bf16_f32 v17, v98, v99
    v_cvt_pk_bf16_f32 v18, v100, v101
    v_cvt_pk_bf16_f32 v19, v102, v103
    v_dot2_f32_bf16 v40, v16, v16, v40
    v_dot2_f32_bf16 v41, v17, v17, v41
    v_dot2_f32_bf16 v42, v18, v18, v42
    v_dot2_f32_bf16 v43, v19, v19, v43
    s_waitcnt vmcnt(4)
    v_lshlrev_b32 v96, 16, v20
    v_and_b32 v97, 0xffff0000, v20
    v_lshlrev_b32 v98, 16, v21
    v_and_b32 v99, 0xffff0000, v21
    v_lshlrev_b32 v100, 16, v22
    v_and_b32 v101, 0xffff0000, v22
    v_lshlrev_b32 v102, 16, v23
    v_and_b32 v103, 0xffff0000, v23
    v_mul_f32 v96, s34, v96
    v_mul_f32 v97, s34, v97
    v_mul_f32 v98, s34, v98
    v_mul_f32 v99, s34, v99
    v_mul_f32 v100, s34, v100
    v_mul_f32 v101, s34, v101
    v_mul_f32 v102, s34, v102
    v_mul_f32 v103, s34, v103
    v_cvt_pk_bf16_f32 v20, v96, v97
    v_cvt_pk_bf16_f32 v21, v98, v99
    v_cvt_pk_bf16_f32 v22, v100, v101
    v_cvt_pk_bf16_f32 v23, v102, v103
    v_dot2_f32_bf16 v40, v20, v20, v40
    v_dot2_f32_bf16 v41, v21, v21, v41
    v_dot2_f32_bf16 v42, v22, v22, v42
    v_dot2_f32_bf16 v43, v23, v23, v43
    s_waitcnt vmcnt(3)
    v_lshlrev_b32 v96, 16, v24
    v_and_b32 v97, 0xffff0000, v24
    v_lshlrev_b32 v98, 16, v25
    v_and_b32 v99, 0xffff0000, v25
    v_lshlrev_b32 v100, 16, v26
    v_and_b32 v101, 0xffff0000, v26
    v_lshlrev_b32 v102, 16, v27
    v_and_b32 v103, 0xffff0000, v27
    v_mul_f32 v96, s34, v96
    v_mul_f32 v97, s34, v97
    v_mul_f32 v98, s34, v98
    v_mul_f32 v99, s34, v99
    v_mul_f32 v100, s34, v100
    v_mul_f32 v101, s34, v101
    v_mul_f32 v102, s34, v102
    v_mul_f32 v103, s34, v103
    v_cvt_pk_bf16_f32 v24, v96, v97
    v_cvt_pk_bf16_f32 v25, v98, v99
    v_cvt_pk_bf16_f32 v26, v100, v101
    v_cvt_pk_bf16_f32 v27, v102, v103
    v_dot2_f32_bf16 v40, v24, v24, v40
    v_dot2_f32_bf16 v41, v25, v25, v41
    v_dot2_f32_bf16 v42, v26, v26, v42
    v_dot2_f32_bf16 v43, v27, v27, v43
    s_waitcnt vmcnt(2)
    v_lshlrev_b32 v96, 16, v28
    v_and_b32 v97, 0xffff0000, v28
    v_lshlrev_b32 v98, 16, v29
    v_and_b32 v99, 0xffff0000, v29
    v_lshlrev_b32 v100, 16, v30
    v_and_b32 v101, 0xffff0000, v30
    v_lshlrev_b32 v102, 16, v31
    v_and_b32 v103, 0xffff0000, v31
    v_mul_f32 v96, s34, v96
    v_mul_f32 v97, s34, v97
    v_mul_f32 v98, s34, v98
    v_mul_f32 v99, s34, v99
    v_mul_f32 v100, s34, v100
    v_mul_f32 v101, s34, v101
    v_mul_f32 v102, s34, v102
    v_mul_f32 v103, s34, v103
    v_cvt_pk_bf16_f32 v28, v96, v97
    v_cvt_pk_bf16_f32 v29, v98, v99
    v_cvt_pk_bf16_f32 v30, v100, v101
    v_cvt_pk_bf16_f32 v31, v102, v103
    v_dot2_f32_bf16 v40, v28, v28, v40
    v_dot2_f32_bf16 v41, v29, v29, v41
    v_dot2_f32_bf16 v42, v30, v30, v42
    v_dot2_f32_bf16 v43, v31, v31, v43
    s_waitcnt vmcnt(1)
    v_lshlrev_b32 v96, 16, v32
    v_and_b32 v97, 0xffff0000, v32
    v_lshlrev_b32 v98, 16, v33
    v_and_b32 v99, 0xffff0000, v33
    v_lshlrev_b32 v100, 16, v34
    v_and_b32 v101, 0xffff0000, v34
    v_lshlrev_b32 v102, 16, v35
    v_and_b32 v103, 0xffff0000, v35
    v_mul_f32 v96, s34, v96
    v_mul_f32 v97, s34, v97
    v_mul_f32 v98, s34, v98
    v_mul_f32 v99, s34, v99
    v_mul_f32 v100, s34, v100
    v_mul_f32 v101, s34, v101
    v_mul_f32 v102, s34, v102
    v_mul_f32 v103, s34, v103
    v_cvt_pk_bf16_f32 v32, v96, v97
    v_cvt_pk_bf16_f32 v33, v98, v99
    v_cvt_pk_bf16_f32 v34, v100, v101
    v_cvt_pk_bf16_f32 v35, v102, v103
    v_dot2_f32_bf16 v40, v32, v32, v40
    v_dot2_f32_bf16 v41, v33, v33, v41
    v_dot2_f32_bf16 v42, v34, v34, v42
    v_dot2_f32_bf16 v43, v35, v35, v43
    s_waitcnt vmcnt(0)
    v_lshlrev_b32 v96, 16, v36
    v_and_b32 v97, 0xffff0000, v36
    v_lshlrev_b32 v98, 16, v37
    v_and_b32 v99, 0xffff0000, v37
    v_lshlrev_b32 v100, 16, v38
    v_and_b32 v101, 0xffff0000, v38
    v_lshlrev_b32 v102, 16, v39
    v_and_b32 v103, 0xffff0000, v39
    v_mul_f32 v96, s34, v96
    v_mul_f32 v97, s34, v97
    v_mul_f32 v98, s34, v98
    v_mul_f32 v99, s34, v99
    v_mul_f32 v100, s34, v100
    v_mul_f32 v101, s34, v101
    v_mul_f32 v102, s34, v102
    v_mul_f32 v103, s34, v103
    v_cvt_pk_bf16_f32 v36, v96, v97
    v_cvt_pk_bf16_f32 v37, v98, v99
    v_cvt_pk_bf16_f32 v38, v100, v101
    v_cvt_pk_bf16_f32 v39, v102, v103
    v_dot2_f32_bf16 v40, v36, v36, v40
    v_dot2_f32_bf16 v41, v37, v37, v41
    v_dot2_f32_bf16 v42, v38, v38, v42
    v_dot2_f32_bf16 v43, v39, v39, v43
    s_nop 3
    v_add_f32 v40, v40, v41
    v_add_f32 v42, v42, v43
    v_add_f32 v40, v40, v42
    v_mov_b32 v41, v40
    s_nop 1
    v_permlane32_swap_b32 v40, v41
    v_add_f32 v40, v40, v41
    v_mov_b32 v41, v40
    s_nop 1
    v_permlane16_swap_b32 v40, v41
    v_add_f32 v40, v40, v41
    v_cvt_pk_bf16_f32 v41, v40, v40
    v_lshlrev_b32 v44, 16, v41
    ds_read_b128 v[64:67], v11 offset:0
    ds_read_b128 v[68:71], v11 offset:1024
    ds_read_b128 v[72:75], v11 offset:2048
    ds_read_b128 v[76:79], v11 offset:3072
    ds_read_b128 v[80:83], v11 offset:4096
    ds_read_b128 v[84:87], v11 offset:5120
    s_waitcnt lgkmcnt(5)
    v_mfma_f32_16x16x32_bf16 v[48:51], v[64:67], v[16:19], 0
    ds_read_b128 v[64:67], v11 offset:6144
    s_waitcnt lgkmcnt(5)
    v_mfma_f32_16x16x32_bf16 v[48:51], v[68:71], v[20:23], v[48:51]
    ds_read_b128 v[68:71], v11 offset:7168
    s_waitcnt lgkmcnt(5)
    v_mfma_f32_16x16x32_bf16 v[48:51], v[72:75], v[24:27], v[48:51]
    ds_read_b128 v[72:75], v11 offset:8192
    s_waitcnt lgkmcnt(5)
    v_mfma_f32_16x16x32_bf16 v[48:51], v[76:79], v[28:31], v[48:51]
    ds_read_b128 v[76:79], v11 offset:9216
    s_waitcnt lgkmcnt(5)
    v_mfma_f32_16x16x32_bf16 v[48:51], v[80:83], v[32:35], v[48:51]
    ds_read_b128 v[80:83], v11 offset:10240
    s_waitcnt lgkmcnt(5)
    v_mfma_f32_16x16x32_bf16 v[48:51], v[84:87], v[36:39], v[48:51]
    ds_read_b128 v[84:87], v11 offset:11264
    s_waitcnt lgkmcnt(5)
    v_mfma_f32_16x16x32_bf16 v[52:55], v[64:67], v[16:19], 0
    ds_read_b128 v[64:67], v11 offset:12288
    s_waitcnt lgkmcnt(5)
    v_mfma_f32_16x16x32_bf16 v[52:55], v[68:71], v[20:23], v[52:55]
    ds_read_b128 v[68:71], v11 offset:13312
    s_waitcnt lgkmcnt(5)
    v_mfma_f32_16x16x32_bf16 v[52:55], v[72:75], v[24:27], v[52:55]
    ds_read_b128 v[72:75], v11 offset:14336
    s_waitcnt lgkmcnt(5)
    v_mfma_f32_16x16x32_bf16 v[52:55], v[76:79], v[28:31], v[52:55]
    ds_read_b128 v[76:79], v11 offset:15360
    s_waitcnt lgkmcnt(5)
    v_mfma_f32_16x16x32_bf16 v[52:55], v[80:83], v[32:35], v[52:55]
    ds_read_b128 v[80:83], v11 offset:16384
    s_waitcnt lgkmcnt(5)
    v_mfma_f32_16x16x32_bf16 v[52:55], v[84:87], v[36:39], v[52:55]
    ds_read_b128 v[84:87], v11 offset:17408
    s_waitcnt lgkmcnt(5)
    v_mfma_f32_16x16x32_bf16 v[56:59], v[64:67], v[16:19], 0
    ds_read_b128 v[64:67], v11 offset:18432
    s_waitcnt lgkmcnt(5)
    v_mfma_f32_16x16x32_bf16 v[56:59], v[68:71], v[20:23], v[56:59]
    ds_read_b128 v[68:71], v11 offset:19456
    s_waitcnt lgkmcnt(5)
    v_mfma_f32_16x16x32_bf16 v[56:59], v[72:75], v[24:27], v[56:59]
    ds_read_b128 v[72:75], v11 offset:20480
    s_waitcnt lgkmcnt(5)
    v_mfma_f32_16x16x32_bf16 v[56:59], v[76:79], v[28:31], v[56:59]
    ds_read_b128 v[76:79], v11 offset:21504
    s_waitcnt lgkmcnt(5)
    v_mfma_f32_16x16x32_bf16 v[56:59], v[80:83], v[32:35], v[56:59]
    ds_read_b128 v[80:83], v11 offset:22528
    s_waitcnt lgkmcnt(5)
    v_mfma_f32_16x16x32_bf16 v[56:59], v[84:87], v[36:39], v[56:59]
    ds_read_b128 v[84:87], v11 offset:23552
    s_waitcnt lgkmcnt(5)
    v_mfma_f32_16x16x32_bf16 v[60:63], v[64:67], v[16:19], 0
    s_waitcnt lgkmcnt(4)
    v_mfma_f32_16x16x32_bf16 v[60:63], v[68:71], v[20:23], v[60:63]
    s_waitcnt lgkmcnt(3)
    v_mfma_f32_16x16x32_bf16 v[60:63], v[72:75], v[24:27], v[60:63]
    s_waitcnt lgkmcnt(2)
    v_mfma_f32_16x16x32_bf16 v[60:63], v[76:79], v[28:31], v[60:63]
    s_waitcnt lgkmcnt(1)
    v_mfma_f32_16x16x32_bf16 v[60:63], v[80:83], v[32:35], v[60:63]
    s_waitcnt lgkmcnt(0)
    v_mfma_f32_16x16x32_bf16 v[60:63], v[84:87], v[36:39], v[60:63]
    v_cvt_pk_bf16_f32 v96, v48, v49
    v_cvt_pk_bf16_f32 v97, v50, v51
    v_lshlrev_b32 v98, 16, v96
    v_and_b32 v99, 0xffff0000, v96
    v_lshlrev_b32 v100, 16, v97
    v_and_b32 v101, 0xffff0000, v97
    v_fma_f32 v98, v44, -0.5, v98
    v_fma_f32 v99, v44, -0.5, v99
    v_fma_f32 v100, v44, -0.5, v100
    v_fma_f32 v101, v44, -0.5, v101
    v_cvt_pk_bf16_f32 v96, v98, v99
    v_cvt_pk_bf16_f32 v97, v100, v101
    v_lshlrev_b32 v98, 16, v96
    v_and_b32 v99, 0xffff0000, v96
    v_lshlrev_b32 v100, 16, v97
    v_and_b32 v101, 0xffff0000, v97
    v_mul_f32 v102, s35, v98
    v_mul_f32 v103, s35, v99
    v_mul_f32 v104, s35, v100
    v_mul_f32 v105, s35, v101
    v_fma_f32 v106, v98, s35, -v102
    v_fma_f32 v107, v99, s35, -v103
    v_fma_f32 v108, v100, s35, -v104
    v_fma_f32 v109, v101, s35, -v105
    v_fma_f32 v106, v98, s36, v106
    v_fma_f32 v107, v99, s36, v107
    v_fma_f32 v108, v100, s36, v108
    v_fma_f32 v109, v101, s36, v109
    v_exp_f32 v102, v102
    v_exp_f32 v103, v103
    v_exp_f32 v104, v104
    v_exp_f32 v105, v105
    v_mul_f32 v106, s37, v106
    v_mul_f32 v107, s37, v107
    v_mul_f32 v108, s37, v108
    v_mul_f32 v109, s37, v109
    v_fma_f32 v102, v102, v106, v102
    v_fma_f32 v103, v103, v107, v103
    v_fma_f32 v104, v104, v108, v104
    v_fma_f32 v105, v105, v109, v105
    v_cvt_pk_bf16_f32 v96, v102, v103
    v_cvt_pk_bf16_f32 v97, v104, v105
    v_lshlrev_b32 v98, 16, v96
    v_and_b32 v99, 0xffff0000, v96
    v_lshlrev_b32 v100, 16, v97
    v_and_b32 v101, 0xffff0000, v97
    v_fma_f32 v98, v98, v45, v46
    v_fma_f32 v99, v99, v45, v46
    v_fma_f32 v100, v100, v45, v46
    v_fma_f32 v101, v101, v45, v46
    v_cvt_pk_bf16_f32 v88, v98, v99
    v_cvt_pk_bf16_f32 v89, v100, v101
    v_cvt_pk_bf16_f32 v96, v52, v53
    v_cvt_pk_bf16_f32 v97, v54, v55
    v_lshlrev_b32 v98, 16, v96
    v_and_b32 v99, 0xffff0000, v96
    v_lshlrev_b32 v100, 16, v97
    v_and_b32 v101, 0xffff0000, v97
    v_fma_f32 v98, v44, -0.5, v98
    v_fma_f32 v99, v44, -0.5, v99
    v_fma_f32 v100, v44, -0.5, v100
    v_fma_f32 v101, v44, -0.5, v101
    v_cvt_pk_bf16_f32 v96, v98, v99
    v_cvt_pk_bf16_f32 v97, v100, v101
    v_lshlrev_b32 v98, 16, v96
    v_and_b32 v99, 0xffff0000, v96
    v_lshlrev_b32 v100, 16, v97
    v_and_b32 v101, 0xffff0000, v97
    v_mul_f32 v102, s35, v98
    v_mul_f32 v103, s35, v99
    v_mul_f32 v104, s35, v100
    v_mul_f32 v105, s35, v101
    v_fma_f32 v106, v98, s35, -v102
    v_fma_f32 v107, v99, s35, -v103
    v_fma_f32 v108, v100, s35, -v104
    v_fma_f32 v109, v101, s35, -v105
    v_fma_f32 v106, v98, s36, v106
    v_fma_f32 v107, v99, s36, v107
    v_fma_f32 v108, v100, s36, v108
    v_fma_f32 v109, v101, s36, v109
    v_exp_f32 v102, v102
    v_exp_f32 v103, v103
    v_exp_f32 v104, v104
    v_exp_f32 v105, v105
    v_mul_f32 v106, s37, v106
    v_mul_f32 v107, s37, v107
    v_mul_f32 v108, s37, v108
    v_mul_f32 v109, s37, v109
    v_fma_f32 v102, v102, v106, v102
    v_fma_f32 v103, v103, v107, v103
    v_fma_f32 v104, v104, v108, v104
    v_fma_f32 v105, v105, v109, v105
    v_cvt_pk_bf16_f32 v96, v102, v103
    v_cvt_pk_bf16_f32 v97, v104, v105
    v_lshlrev_b32 v98, 16, v96
    v_and_b32 v99, 0xffff0000, v96
    v_lshlrev_b32 v100, 16, v97
    v_and_b32 v101, 0xffff0000, v97
    v_fma_f32 v98, v98, v45, v46
    v_fma_f32 v99, v99, v45, v46
    v_fma_f32 v100, v100, v45, v46
    v_fma_f32 v101, v101, v45, v46
    v_cvt_pk_bf16_f32 v90, v98, v99
    v_cvt_pk_bf16_f32 v91, v100, v101
    v_cvt_pk_bf16_f32 v96, v56, v57
    v_cvt_pk_bf16_f32 v97, v58, v59
    v_lshlrev_b32 v98, 16, v96
    v_and_b32 v99, 0xffff0000, v96
    v_lshlrev_b32 v100, 16, v97
    v_and_b32 v101, 0xffff0000, v97
    v_fma_f32 v98, v44, -0.5, v98
    v_fma_f32 v99, v44, -0.5, v99
    v_fma_f32 v100, v44, -0.5, v100
    v_fma_f32 v101, v44, -0.5, v101
    v_cvt_pk_bf16_f32 v96, v98, v99
    v_cvt_pk_bf16_f32 v97, v100, v101
    v_lshlrev_b32 v98, 16, v96
    v_and_b32 v99, 0xffff0000, v96
    v_lshlrev_b32 v100, 16, v97
    v_and_b32 v101, 0xffff0000, v97
    v_mul_f32 v102, s35, v98
    v_mul_f32 v103, s35, v99
    v_mul_f32 v104, s35, v100
    v_mul_f32 v105, s35, v101
    v_fma_f32 v106, v98, s35, -v102
    v_fma_f32 v107, v99, s35, -v103
    v_fma_f32 v108, v100, s35, -v104
    v_fma_f32 v109, v101, s35, -v105
    v_fma_f32 v106, v98, s36, v106
    v_fma_f32 v107, v99, s36, v107
    v_fma_f32 v108, v100, s36, v108
    v_fma_f32 v109, v101, s36, v109
    v_exp_f32 v102, v102
    v_exp_f32 v103, v103
    v_exp_f32 v104, v104
    v_exp_f32 v105, v105
    v_mul_f32 v106, s37, v106
    v_mul_f32 v107, s37, v107
    v_mul_f32 v108, s37, v108
    v_mul_f32 v109, s37, v109
    v_fma_f32 v102, v102, v106, v102
    v_fma_f32 v103, v103, v107, v103
    v_fma_f32 v104, v104, v108, v104
    v_fma_f32 v105, v105, v109, v105
    v_cvt_pk_bf16_f32 v96, v102, v103
    v_cvt_pk_bf16_f32 v97, v104, v105
    v_lshlrev_b32 v98, 16, v96
    v_and_b32 v99, 0xffff0000, v96
    v_lshlrev_b32 v100, 16, v97
    v_and_b32 v101, 0xffff0000, v97
    v_fma_f32 v98, v98, v45, v46
    v_fma_f32 v99, v99, v45, v46
    v_fma_f32 v100, v100, v45, v46
    v_fma_f32 v101, v101, v45, v46
    v_cvt_pk_bf16_f32 v92, v98, v99
    v_cvt_pk_bf16_f32 v93, v100, v101
    v_cvt_pk_bf16_f32 v96, v60, v61
    v_cvt_pk_bf16_f32 v97, v62, v63
    v_lshlrev_b32 v98, 16, v96
    v_and_b32 v99, 0xffff0000, v96
    v_lshlrev_b32 v100, 16, v97
    v_and_b32 v101, 0xffff0000, v97
    v_fma_f32 v98, v44, -0.5, v98
    v_fma_f32 v99, v44, -0.5, v99
    v_fma_f32 v100, v44, -0.5, v100
    v_fma_f32 v101, v44, -0.5, v101
    v_cvt_pk_bf16_f32 v96, v98, v99
    v_cvt_pk_bf16_f32 v97, v100, v101
    v_lshlrev_b32 v98, 16, v96
    v_and_b32 v99, 0xffff0000, v96
    v_lshlrev_b32 v100, 16, v97
    v_and_b32 v101, 0xffff0000, v97
    v_mul_f32 v102, s35, v98
    v_mul_f32 v103, s35, v99
    v_mul_f32 v104, s35, v100
    v_mul_f32 v105, s35, v101
    v_fma_f32 v106, v98, s35, -v102
    v_fma_f32 v107, v99, s35, -v103
    v_fma_f32 v108, v100, s35, -v104
    v_fma_f32 v109, v101, s35, -v105
    v_fma_f32 v106, v98, s36, v106
    v_fma_f32 v107, v99, s36, v107
    v_fma_f32 v108, v100, s36, v108
    v_fma_f32 v109, v101, s36, v109
    v_exp_f32 v102, v102
    v_exp_f32 v103, v103
    v_exp_f32 v104, v104
    v_exp_f32 v105, v105
    v_mul_f32 v106, s37, v106
    v_mul_f32 v107, s37, v107
    v_mul_f32 v108, s37, v108
    v_mul_f32 v109, s37, v109
    v_fma_f32 v102, v102, v106, v102
    v_fma_f32 v103, v103, v107, v103
    v_fma_f32 v104, v104, v108, v104
    v_fma_f32 v105, v105, v109, v105
    v_cvt_pk_bf16_f32 v96, v102, v103
    v_cvt_pk_bf16_f32 v97, v104, v105
    v_lshlrev_b32 v98, 16, v96
    v_and_b32 v99, 0xffff0000, v96
    v_lshlrev_b32 v100, 16, v97
    v_and_b32 v101, 0xffff0000, v97
    v_fma_f32 v98, v98, v45, v46
    v_fma_f32 v99, v99, v45, v46
    v_fma_f32 v100, v100, v45, v46
    v_fma_f32 v101, v101, v45, v46
    v_cvt_pk_bf16_f32 v94, v98, v99
    v_cvt_pk_bf16_f32 v95, v100, v101
    s_cmp_lt_u32 s28, 12
    s_cbranch_scc1 L_f_consumer
    s_cmp_lg_u32 s28, 12
    s_cbranch_scc1 L_f_hwait
    s_lshl_b32 s32, s29, 8
    s_add_u32 s32, s32, 17825792
    v_mov_b32 v7, s32
    s_mov_b32 s56, 0x40000
L_f_poll:
    buffer_load_dword v8, v7, s[24:27], 0 offen sc1
    s_waitcnt vmcnt(0)
    v_readfirstlane_b32 s57, v8
    s_nop 3
    s_cmp_ge_u32 s57, 8
    s_cbranch_scc1 L_f_pollok
    s_sub_u32 s56, s56, 1
    s_cmp_lg_u32 s56, 0
    s_cbranch_scc1 L_f_poll
L_f_pollok:
    v_mov_b32 v8, 1
    ds_write_b32 v6, v8 offset:20
    s_branch L_f_polled
L_f_hwait:
    s_mov_b32 s56, 0x100000
L_f_hspin:
    ds_read_b32 v8, v6 offset:20
    s_waitcnt lgkmcnt(0)
    v_readfirstlane_b32 s57, v8
    s_nop 3
    s_cmp_lg_u32 s57, 0
    s_cbranch_scc1 L_f_polled
    s_sub_u32 s56, s56, 1
    s_cmp_lg_u32 s56, 0
    s_cbranch_scc1 L_f_hspin
L_f_polled:
    s_sub_u32 s41, s28, 12
    s_mul_i32 s41, s41, 7168
    s_add_u32 s32, s42, s41
    s_add_u32 s33, s32, 4096
    v_add_u32 v8, s41, v11
    buffer_load_dwordx4 v[16:19], v11, s[24:27], s32 offen offset:0 sc1
    buffer_load_dwordx4 v[20:23], v11, s[24:27], s32 offen offset:1024 sc1
    buffer_load_dwordx4 v[24:27], v11, s[24:27], s32 offen offset:2048 sc1
    buffer_load_dwordx4 v[28:31], v11, s[24:27], s32 offen offset:3072 sc1
    s_cmp_eq_u32 s28, 15
    s_cbranch_scc1 L_f_last5
    buffer_load_dwordx4 v[32:35], v11, s[24:27], s33 offen offset:0 sc1
    buffer_load_dwordx4 v[36:39], v11, s[24:27], s33 offen offset:1024 sc1
    buffer_load_dwordx4 v[40:43], v11, s[24:27], s33 offen offset:2048 sc1
    s_waitcnt vmcnt(0)
    ds_write_b128 v8, v[16:19] offset:24576
    ds_write_b128 v8, v[20:23] offset:25600
    ds_write_b128 v8, v[24:27] offset:26624
    ds_write_b128 v8, v[28:31] offset:27648
    ds_write_b128 v8, v[32:35] offset:28672
    ds_write_b128 v8, v[36:39] offset:29696
    ds_write_b128 v8, v[40:43] offset:30720
    s_branch L_f_fetched
L_f_last5:
    buffer_load_dwordx4 v[32:35], v11, s[24:27], s33 offen sc1
    s_waitcnt vmcnt(0)
    ds_write_b128 v8, v[16:19] offset:24576
    ds_write_b128 v8, v[20:23] offset:25600
    ds_write_b128 v8, v[24:27] offset:26624
    ds_write_b128 v8, v[28:31] offset:27648
    ds_write_b128 v8, v[32:35] offset:28672
L_f_fetched:
    s_waitcnt lgkmcnt(0)
    s_sub_u32 s41, s28, 12
    s_lshl_b32 s41, s41, 2
    v_add_u32 v7, s41, v6
    v_mov_b32 v8, 1
    ds_write_b32 v7, v8
    s_waitcnt lgkmcnt(0)
L_f_consumer:
    s_mov_b32 s56, 0x100000
L_f_spin:
    ds_read_b128 v[100:103], v6
    s_waitcnt lgkmcnt(0)
    v_and_b32 v100, v100, v101
    v_and_b32 v102, v102, v103
    v_and_b32 v100, v100, v102
    s_nop 0
    v_readfirstlane_b32 s57, v100
    s_nop 3
    s_cmp_lg_u32 s57, 0
    s_cbranch_scc1 L_f_go
    s_sub_u32 s56, s56, 1
    s_cmp_lg_u32 s56, 0
    s_cbranch_scc1 L_f_spin
L_f_go:
    ds_read_b128 v[64:67], v11 offset:49152
    ds_read_b128 v[68:71], v11 offset:50176
    ds_read_b128 v[72:75], v11 offset:24576
    ds_read_b128 v[76:79], v11 offset:25600
    ds_read_b128 v[80:83], v11 offset:26624
    ds_read_b128 v[84:87], v11 offset:27648
    s_waitcnt lgkmcnt(5)
    v_mfma_f32_16x16x32_bf16 v[120:123], v[64:67], v[88:91], 0
    ds_read_b128 v[64:67], v11 offset:28672
    s_waitcnt lgkmcnt(5)
    v_mfma_f32_16x16x32_bf16 v[120:123], v[68:71], v[92:95], v[120:123]
    ds_read_b128 v[68:71], v11 offset:29696
    s_waitcnt lgkmcnt(5)
    v_mfma_f32_16x16x32_bf16 v[16:19], v[72:75], v[88:91], 0
    ds_read_b128 v[72:75], v11 offset:30720
    s_waitcnt lgkmcnt(5)
    v_mfma_f32_16x16x32_bf16 v[16:19], v[76:79], v[92:95], v[16:19]
    ds_read_b128 v[76:79], v11 offset:31744
    s_waitcnt lgkmcnt(5)
    v_mfma_f32_16x16x32_bf16 v[20:23], v[80:83], v[88:91], 0
    ds_read_b128 v[80:83], v11 offset:32768
    s_waitcnt lgkmcnt(5)
    v_mfma_f32_16x16x32_bf16 v[20:23], v[84:87], v[92:95], v[20:23]
    ds_read_b128 v[84:87], v11 offset:33792
    s_waitcnt lgkmcnt(5)
    v_mfma_f32_16x16x32_bf16 v[24:27], v[64:67], v[88:91], 0
    ds_read_b128 v[64:67], v11 offset:34816
    s_waitcnt lgkmcnt(5)
    v_mfma_f32_16x16x32_bf16 v[24:27], v[68:71], v[92:95], v[24:27]
    ds_read_b128 v[68:71], v11 offset:35840
    s_waitcnt lgkmcnt(5)
    v_mfma_f32_16x16x32_bf16 v[28:31], v[72:75], v[88:91], 0
    ds_read_b128 v[72:75], v11 offset:36864
    s_waitcnt lgkmcnt(5)
    v_mfma_f32_16x16x32_bf16 v[28:31], v[76:79], v[92:95], v[28:31]
    ds_read_b128 v[76:79], v11 offset:37888
    s_waitcnt lgkmcnt(5)
    v_mfma_f32_16x16x32_bf16 v[32:35], v[80:83], v[88:91], 0
    ds_read_b128 v[80:83], v11 offset:38912
    s_waitcnt lgkmcnt(5)
    v_mfma_f32_16x16x32_bf16 v[32:35], v[84:87], v[92:95], v[32:35]
    ds_read_b128 v[84:87], v11 offset:39936
    s_waitcnt lgkmcnt(5)
    v_mfma_f32_16x16x32_bf16 v[36:39], v[64:67], v[88:91], 0
    ds_read_b128 v[64:67], v11 offset:40960
    s_waitcnt lgkmcnt(5)
    v_mfma_f32_16x16x32_bf16 v[36:39], v[68:71], v[92:95], v[36:39]
    ds_read_b128 v[68:71], v11 offset:41984
    s_waitcnt lgkmcnt(5)
    v_mfma_f32_16x16x32_bf16 v[48:51], v[72:75], v[88:91], 0
    ds_read_b128 v[72:75], v11 offset:43008
    s_waitcnt lgkmcnt(5)
    v_mfma_f32_16x16x32_bf16 v[48:51], v[76:79], v[92:95], v[48:51]
    ds_read_b128 v[76:79], v11 offset:44032
    s_waitcnt lgkmcnt(5)
    v_mfma_f32_16x16x32_bf16 v[52:55], v[80:83], v[88:91], 0
    ds_read_b128 v[80:83], v11 offset:45056
    s_waitcnt lgkmcnt(5)
    v_mfma_f32_16x16x32_bf16 v[52:55], v[84:87], v[92:95], v[52:55]
    ds_read_b128 v[84:87], v11 offset:46080
    s_waitcnt lgkmcnt(5)
    v_mfma_f32_16x16x32_bf16 v[56:59], v[64:67], v[88:91], 0
    ds_read_b128 v[64:67], v11 offset:47104
    s_waitcnt lgkmcnt(5)
    v_mfma_f32_16x16x32_bf16 v[56:59], v[68:71], v[92:95], v[56:59]
    ds_read_b128 v[68:71], v11 offset:48128
    s_waitcnt lgkmcnt(5)
    v_mfma_f32_16x16x32_bf16 v[60:63], v[72:75], v[88:91], 0
    s_waitcnt lgkmcnt(4)
    v_mfma_f32_16x16x32_bf16 v[60:63], v[76:79], v[92:95], v[60:63]
    s_waitcnt lgkmcnt(3)
    v_mfma_f32_16x16x32_bf16 v[112:115], v[80:83], v[88:91], 0
    s_waitcnt lgkmcnt(2)
    v_mfma_f32_16x16x32_bf16 v[112:115], v[84:87], v[92:95], v[112:115]
    s_waitcnt lgkmcnt(1)
    v_mfma_f32_16x16x32_bf16 v[116:119], v[64:67], v[88:91], 0
    s_waitcnt lgkmcnt(0)
    v_mfma_f32_16x16x32_bf16 v[116:119], v[68:71], v[92:95], v[116:119]
    s_nop 7
    s_nop 1
    v_cvt_pk_bf16_f32 v96, v120, v120
    v_lshlrev_b32 v96, 16, v96
    v_add_f32 v96, v46, v96
    v_cvt_pk_bf16_f32 v96, v96, v96
    v_lshlrev_b32 v96, 16, v96
    v_rcp_f32 v97, v96
    v_cvt_pk_bf16_f32 v80, v16, v17
    v_cvt_pk_bf16_f32 v81, v18, v19
    v_cvt_pk_bf16_f32 v82, v20, v21
    v_cvt_pk_bf16_f32 v83, v22, v23
    v_lshlrev_b32 v64, 16, v80
    v_and_b32 v65, 0xffff0000, v80
    v_lshlrev_b32 v66, 16, v81
    v_and_b32 v67, 0xffff0000, v81
    v_lshlrev_b32 v68, 16, v82
    v_and_b32 v69, 0xffff0000, v82
    v_lshlrev_b32 v70, 16, v83
    v_and_b32 v71, 0xffff0000, v83
    v_mul_f32 v72, v64, v97
    v_mul_f32 v73, v65, v97
    v_mul_f32 v74, v66, v97
    v_mul_f32 v75, v67, v97
    v_mul_f32 v76, v68, v97
    v_mul_f32 v77, v69, v97
    v_mul_f32 v78, v70, v97
    v_mul_f32 v79, v71, v97
    v_fma_f32 v64, -v72, v96, v64
    v_fma_f32 v65, -v73, v96, v65
    v_fma_f32 v66, -v74, v96, v66
    v_fma_f32 v67, -v75, v96, v67
    v_fma_f32 v68, -v76, v96, v68
    v_fma_f32 v69, -v77, v96, v69
    v_fma_f32 v70, -v78, v96, v70
    v_fma_f32 v71, -v79, v96, v71
    v_fma_f32 v72, v64, v97, v72
    v_fma_f32 v73, v65, v97, v73
    v_fma_f32 v74, v66, v97, v74
    v_fma_f32 v75, v67, v97, v75
    v_fma_f32 v76, v68, v97, v76
    v_fma_f32 v77, v69, v97, v77
    v_fma_f32 v78, v70, v97, v78
    v_fma_f32 v79, v71, v97, v79
    v_cvt_pk_bf16_f32 v100, v72, v73
    v_cvt_pk_bf16_f32 v101, v74, v75
    v_cvt_pk_bf16_f32 v102, v76, v77
    v_cvt_pk_bf16_f32 v103, v78, v79
    buffer_store_dwordx4 v[100:103], v2, s[16:19], s31 offen offset:0 nt
    v_cvt_pk_bf16_f32 v80, v24, v25
    v_cvt_pk_bf16_f32 v81, v26, v27
    v_cvt_pk_bf16_f32 v82, v28, v29
    v_cvt_pk_bf16_f32 v83, v30, v31
    v_lshlrev_b32 v64, 16, v80
    v_and_b32 v65, 0xffff0000, v80
    v_lshlrev_b32 v66, 16, v81
    v_and_b32 v67, 0xffff0000, v81
    v_lshlrev_b32 v68, 16, v82
    v_and_b32 v69, 0xffff0000, v82
    v_lshlrev_b32 v70, 16, v83
    v_and_b32 v71, 0xffff0000, v83
    v_mul_f32 v72, v64, v97
    v_mul_f32 v73, v65, v97
    v_mul_f32 v74, v66, v97
    v_mul_f32 v75, v67, v97
    v_mul_f32 v76, v68, v97
    v_mul_f32 v77, v69, v97
    v_mul_f32 v78, v70, v97
    v_mul_f32 v79, v71, v97
    v_fma_f32 v64, -v72, v96, v64
    v_fma_f32 v65, -v73, v96, v65
    v_fma_f32 v66, -v74, v96, v66
    v_fma_f32 v67, -v75, v96, v67
    v_fma_f32 v68, -v76, v96, v68
    v_fma_f32 v69, -v77, v96, v69
    v_fma_f32 v70, -v78, v96, v70
    v_fma_f32 v71, -v79, v96, v71
    v_fma_f32 v72, v64, v97, v72
    v_fma_f32 v73, v65, v97, v73
    v_fma_f32 v74, v66, v97, v74
    v_fma_f32 v75, v67, v97, v75
    v_fma_f32 v76, v68, v97, v76
    v_fma_f32 v77, v69, v97, v77
    v_fma_f32 v78, v70, v97, v78
    v_fma_f32 v79, v71, v97, v79
    v_cvt_pk_bf16_f32 v104, v72, v73
    v_cvt_pk_bf16_f32 v105, v74, v75
    v_cvt_pk_bf16_f32 v106, v76, v77
    v_cvt_pk_bf16_f32 v107, v78, v79
    buffer_store_dwordx4 v[104:107], v2, s[16:19], s31 offen offset:64 nt
    v_cvt_pk_bf16_f32 v80, v32, v33
    v_cvt_pk_bf16_f32 v81, v34, v35
    v_cvt_pk_bf16_f32 v82, v36, v37
    v_cvt_pk_bf16_f32 v83, v38, v39
    v_lshlrev_b32 v64, 16, v80
    v_and_b32 v65, 0xffff0000, v80
    v_lshlrev_b32 v66, 16, v81
    v_and_b32 v67, 0xffff0000, v81
    v_lshlrev_b32 v68, 16, v82
    v_and_b32 v69, 0xffff0000, v82
    v_lshlrev_b32 v70, 16, v83
    v_and_b32 v71, 0xffff0000, v83
    v_mul_f32 v72, v64, v97
    v_mul_f32 v73, v65, v97
    v_mul_f32 v74, v66, v97
    v_mul_f32 v75, v67, v97
    v_mul_f32 v76, v68, v97
    v_mul_f32 v77, v69, v97
    v_mul_f32 v78, v70, v97
    v_mul_f32 v79, v71, v97
    v_fma_f32 v64, -v72, v96, v64
    v_fma_f32 v65, -v73, v96, v65
    v_fma_f32 v66, -v74, v96, v66
    v_fma_f32 v67, -v75, v96, v67
    v_fma_f32 v68, -v76, v96, v68
    v_fma_f32 v69, -v77, v96, v69
    v_fma_f32 v70, -v78, v96, v70
    v_fma_f32 v71, -v79, v96, v71
    v_fma_f32 v72, v64, v97, v72
    v_fma_f32 v73, v65, v97, v73
    v_fma_f32 v74, v66, v97, v74
    v_fma_f32 v75, v67, v97, v75
    v_fma_f32 v76, v68, v97, v76
    v_fma_f32 v77, v69, v97, v77
    v_fma_f32 v78, v70, v97, v78
    v_fma_f32 v79, v71, v97, v79
    v_cvt_pk_bf16_f32 v100, v72, v73
    v_cvt_pk_bf16_f32 v101, v74, v75
    v_cvt_pk_bf16_f32 v102, v76, v77
    v_cvt_pk_bf16_f32 v103, v78, v79
    buffer_store_dwordx4 v[100:103], v2, s[16:19], s31 offen offset:128 nt
    v_cvt_pk_bf16_f32 v80, v48, v49
    v_cvt_pk_bf16_f32 v81, v50, v51
    v_cvt_pk_bf16_f32 v82, v52, v53
    v_cvt_pk_bf16_f32 v83, v54, v55
    v_lshlrev_b32 v64, 16, v80
    v_and_b32 v65, 0xffff0000, v80
    v_lshlrev_b32 v66, 16, v81
    v_and_b32 v67, 0xffff0000, v81
    v_lshlrev_b32 v68, 16, v82
    v_and_b32 v69, 0xffff0000, v82
    v_lshlrev_b32 v70, 16, v83
    v_and_b32 v71, 0xffff0000, v83
    v_mul_f32 v72, v64, v97
    v_mul_f32 v73, v65, v97
    v_mul_f32 v74, v66, v97
    v_mul_f32 v75, v67, v97
    v_mul_f32 v76, v68, v97
    v_mul_f32 v77, v69, v97
    v_mul_f32 v78, v70, v97
    v_mul_f32 v79, v71, v97
    v_fma_f32 v64, -v72, v96, v64
    v_fma_f32 v65, -v73, v96, v65
    v_fma_f32 v66, -v74, v96, v66
    v_fma_f32 v67, -v75, v96, v67
    v_fma_f32 v68, -v76, v96, v68
    v_fma_f32 v69, -v77, v96, v69
    v_fma_f32 v70, -v78, v96, v70
    v_fma_f32 v71, -v79, v96, v71
    v_fma_f32 v72, v64, v97, v72
    v_fma_f32 v73, v65, v97, v73
    v_fma_f32 v74, v66, v97, v74
    v_fma_f32 v75, v67, v97, v75
    v_fma_f32 v76, v68, v97, v76
    v_fma_f32 v77, v69, v97, v77
    v_fma_f32 v78, v70, v97, v78
    v_fma_f32 v79, v71, v97, v79
    v_cvt_pk_bf16_f32 v104, v72, v73
    v_cvt_pk_bf16_f32 v105, v74, v75
    v_cvt_pk_bf16_f32 v106, v76, v77
    v_cvt_pk_bf16_f32 v107, v78, v79
    buffer_store_dwordx4 v[104:107], v2, s[16:19], s31 offen offset:192 nt
    v_cvt_pk_bf16_f32 v80, v56, v57
    v_cvt_pk_bf16_f32 v81, v58, v59
    v_cvt_pk_bf16_f32 v82, v60, v61
    v_cvt_pk_bf16_f32 v83, v62, v63
    v_lshlrev_b32 v64, 16, v80
    v_and_b32 v65, 0xffff0000, v80
    v_lshlrev_b32 v66, 16, v81
    v_and_b32 v67, 0xffff0000, v81
    v_lshlrev_b32 v68, 16, v82
    v_and_b32 v69, 0xffff0000, v82
    v_lshlrev_b32 v70, 16, v83
    v_and_b32 v71, 0xffff0000, v83
    v_mul_f32 v72, v64, v97
    v_mul_f32 v73, v65, v97
    v_mul_f32 v74, v66, v97
    v_mul_f32 v75, v67, v97
    v_mul_f32 v76, v68, v97
    v_mul_f32 v77, v69, v97
    v_mul_f32 v78, v70, v97
    v_mul_f32 v79, v71, v97
    v_fma_f32 v64, -v72, v96, v64
    v_fma_f32 v65, -v73, v96, v65
    v_fma_f32 v66, -v74, v96, v66
    v_fma_f32 v67, -v75, v96, v67
    v_fma_f32 v68, -v76, v96, v68
    v_fma_f32 v69, -v77, v96, v69
    v_fma_f32 v70, -v78, v96, v70
    v_fma_f32 v71, -v79, v96, v71
    v_fma_f32 v72, v64, v97, v72
    v_fma_f32 v73, v65, v97, v73
    v_fma_f32 v74, v66, v97, v74
    v_fma_f32 v75, v67, v97, v75
    v_fma_f32 v76, v68, v97, v76
    v_fma_f32 v77, v69, v97, v77
    v_fma_f32 v78, v70, v97, v78
    v_fma_f32 v79, v71, v97, v79
    v_cvt_pk_bf16_f32 v100, v72, v73
    v_cvt_pk_bf16_f32 v101, v74, v75
    v_cvt_pk_bf16_f32 v102, v76, v77
    v_cvt_pk_bf16_f32 v103, v78, v79
    buffer_store_dwordx4 v[100:103], v2, s[16:19], s31 offen offset:256 nt
    v_cvt_pk_bf16_f32 v80, v112, v113
    v_cvt_pk_bf16_f32 v81, v114, v115
    v_cvt_pk_bf16_f32 v82, v116, v117
    v_cvt_pk_bf16_f32 v83, v118, v119
    v_lshlrev_b32 v64, 16, v80
    v_and_b32 v65, 0xffff0000, v80
    v_lshlrev_b32 v66, 16, v81
    v_and_b32 v67, 0xffff0000, v81
    v_lshlrev_b32 v68, 16, v82
    v_and_b32 v69, 0xffff0000, v82
    v_lshlrev_b32 v70, 16, v83
    v_and_b32 v71, 0xffff0000, v83
    v_mul_f32 v72, v64, v97
    v_mul_f32 v73, v65, v97
    v_mul_f32 v74, v66, v97
    v_mul_f32 v75, v67, v97
    v_mul_f32 v76, v68, v97
    v_mul_f32 v77, v69, v97
    v_mul_f32 v78, v70, v97
    v_mul_f32 v79, v71, v97
    v_fma_f32 v64, -v72, v96, v64
    v_fma_f32 v65, -v73, v96, v65
    v_fma_f32 v66, -v74, v96, v66
    v_fma_f32 v67, -v75, v96, v67
    v_fma_f32 v68, -v76, v96, v68
    v_fma_f32 v69, -v77, v96, v69
    v_fma_f32 v70, -v78, v96, v70
    v_fma_f32 v71, -v79, v96, v71
    v_fma_f32 v72, v64, v97, v72
    v_fma_f32 v73, v65, v97, v73
    v_fma_f32 v74, v66, v97, v74
    v_fma_f32 v75, v67, v97, v75
    v_fma_f32 v76, v68, v97, v76
    v_fma_f32 v77, v69, v97, v77
    v_fma_f32 v78, v70, v97, v78
    v_fma_f32 v79, v71, v97, v79
    v_cvt_pk_bf16_f32 v104, v72, v73
    v_cvt_pk_bf16_f32 v105, v74, v75
    v_cvt_pk_bf16_f32 v106, v76, v77
    v_cvt_pk_bf16_f32 v107, v78, v79
    buffer_store_dwordx4 v[104:107], v2, s[16:19], s31 offen offset:320 nt
L_p2_end:
    s_endpgm
.section .rodata,"a"
.p2align 6
.amdhsa_kernel rfa_phase1_kernel
  .amdhsa_next_free_vgpr 104
  .amdhsa_next_free_sgpr 64
  .amdhsa_accum_offset 104
  .amdhsa_group_segment_fixed_size 0
  .amdhsa_kernarg_size 56
  .amdhsa_user_sgpr_count 2
  .amdhsa_user_sgpr_kernarg_segment_ptr 1
  .amdhsa_system_sgpr_workgroup_id_x 1
.end_amdhsa_kernel
.amdhsa_kernel standalone__linear_kernel_rfa__prompt_kernel
  .amdhsa_next_free_vgpr 124
  .amdhsa_next_free_sgpr 64
  .amdhsa_accum_offset 124
  .amdhsa_group_segment_fixed_size 0
  .amdhsa_kernarg_size 56
  .amdhsa_user_sgpr_count 2
  .amdhsa_user_sgpr_kernarg_segment_ptr 1
  .amdhsa_system_sgpr_workgroup_id_x 1
.end_amdhsa_kernel
```
